```python
import torch

def _softmax(x, axis=-1):
    return torch.softmax(x, dim=axis)
def _gelu(x):
    return torch.nn.functional.gelu(x, approximate="tanh")
def _silu(x):
    return torch.nn.functional.silu(x)
def _sigmoid(x):
    return torch.sigmoid(x)
def _layernorm(x, axis=-1, eps=1e-5):
    m = x.mean(dim=axis, keepdim=True)
    v = x.var(dim=axis, keepdim=True, unbiased=False)
    return (x - m) / torch.sqrt(v + eps)
def _scatter_add(tgt, idx, src, axis=0):
    return tgt.clone().index_add_(axis, idx, src)
def _segment_sum(src, seg, n):
    out = torch.zeros((n,) + src.shape[1:], dtype=src.dtype)
    return out.index_add_(0, seg, src)
def _pad(x, pw):
    flat = tuple(v for pair in reversed(pw) for v in pair)
    return torch.nn.functional.pad(x, flat)

kernel_name = 'recurrent_scan__mha_block_cached__glu_gated_geglu__decode'

def setup_inputs():

    _w = (lambda a: (lambda t: t.to(torch.bfloat16) if t.is_floating_point() else t)(torch.as_tensor(a)))
    def _A_setup():
        B, Sq, D = 2, 1, 640
        H, Sk, Dh = 32, 16384, 128
        return {
            "x": _w((lambda *s: torch.randn(*s, dtype=torch.bfloat16) * 0.4)(B, Sq, D)),
            "k_cache": _w((lambda *s: torch.randn(*s, dtype=torch.bfloat16) * 1.6)(B, H, Sk, Dh)),
            "v_cache": _w((lambda *s: torch.randn(*s, dtype=torch.bfloat16) * 1.6)(B, H, Sk, Dh)),
            "wq": _w((lambda *s: torch.randn(*s, dtype=torch.bfloat16) * 1.6)(D, H * Dh) * (D ** -0.5)),
            "wo": _w((lambda *s: torch.randn(*s, dtype=torch.bfloat16) * 1.6)(H * Dh, D) * ((H * Dh) ** -0.5)),
        }
    _A_in = _A_setup()

    def _B_setup():
        B, S, Dm, Df = 2, 1, 640, 1728
        return {
            "x": _w((lambda *s: torch.randn(*s, dtype=torch.bfloat16) * 0.4)(B, S, Dm)),
            "w_gate": _w((lambda *s: torch.randn(*s, dtype=torch.bfloat16) * 1.6)(Dm, Df) * (Dm ** -0.5)),
            "w_up": _w((lambda *s: torch.randn(*s, dtype=torch.bfloat16) * 1.6)(Dm, Df) * (Dm ** -0.5)),
            "w_down": _w((lambda *s: torch.randn(*s, dtype=torch.bfloat16) * 1.6)(Df, Dm) * (Df ** -0.5)),
        }
    _B_in = _B_setup()

    return {
        "A_x": _A_in["x"],
        "A_k_cache": _A_in["k_cache"],
        "A_v_cache": _A_in["v_cache"],
        "A_wq": _A_in["wq"],
        "A_wo": _A_in["wo"],
        "B_x": _B_in["x"],
        "B_w_gate": _B_in["w_gate"],
        "B_w_up": _B_in["w_up"],
        "B_w_down": _B_in["w_down"],
    }

def reference(A_x, A_k_cache, A_v_cache, A_wq, A_wo, B_x, B_w_gate, B_w_up, B_w_down):
    def _A_ref(x, k_cache, v_cache, wq, wo):
        B, Sq, D = x.shape
        H, Dh = 32, 128
        q = (lambda x, *d: x.permute(*d))((x @ wq).reshape(B, Sq, H, Dh), 0, 2, 1, 3)
        scores = torch.einsum("bhqd,bhkd->bhqk", q, k_cache) * (Dh ** -0.5)
        p = _softmax(scores, axis=-1)
        o = torch.einsum("bhqk,bhkd->bhqd", p, v_cache)
        return (lambda x, *d: x.permute(*d))(o, 0, 2, 1, 3).reshape(B, Sq, H * Dh) @ wo

    def _B_ref(x, w_gate, w_up, w_down):
        g = torch.einsum("bsd,df->bsf", x, w_gate)
        u = torch.einsum("bsd,df->bsf", x, w_up)
        h = _gelu(g) * u
        return torch.einsum("bsf,fd->bsd", h, w_down)

    x = A_x
    xn = _layernorm(x, axis=-1)
    s = _A_ref(xn, A_k_cache, A_v_cache, A_wq, A_wo)
    g = _silu(_B_ref(xn, B_w_gate, B_w_up, B_w_down))
    return x + s * g
```

```asm
; @launch grid=(256,1,1) block=(512,1,1) lds=161280
.amdgcn_target "amdgcn-amd-amdhsa--gfx950"
.text
.globl recurrent_scan__mha_block_cached__glu_gated_geglu__decode_kernel
.p2align 8
.type recurrent_scan__mha_block_cached__glu_gated_geglu__decode_kernel,@function
recurrent_scan__mha_block_cached__glu_gated_geglu__decode_kernel:
    s_cmp_ge_u32 s2, 256
    s_cbranch_scc1 L_end
    s_load_dwordx16 s[16:31], s[0:1], 0
    s_load_dwordx8 s[32:39], s[0:1], 64
    v_lshrrev_b32 v1, 6, v0
    v_and_b32 v0, 63, v0
    v_readfirstlane_b32 s3, v1
    s_lshr_b32 s4, s2, 3
    s_and_b32 s5, s2, 7
    s_cmp_ge_u32 s3, 4
    s_cbranch_scc1 L_service
    v_bfe_u32 v1, v0, 2, 2
    v_lshlrev_b32 v1, 8, v1
    v_lshrrev_b32 v5, 4, v0
    v_lshl_add_u32 v1, v5, 6, v1
    v_and_b32 v6, 3, v0
    v_lshl_add_u32 v1, v6, 4, v1
    v_and_b32 v7, 15, v0
    v_lshlrev_b32 v2, 10, v5
    v_lshl_add_u32 v2, v7, 4, v2
    s_lshl_b32 s55, s4, 22
    s_mul_i32 s78, s5, 80
    s_add_u32 s78, s78, s3
    s_add_u32 s78, s78, 896
    s_lshl_b32 s77, s5, 7
    s_add_u32 s77, s77, s3
    s_waitcnt lgkmcnt(0)
    s_add_u32 s40, s18, s55
    s_addc_u32 s41, s19, 0
    s_mov_b32 s42, 138412032
    s_mov_b32 s43, 0x20000
    s_add_u32 s44, s20, s55
    s_addc_u32 s45, s21, 0
    s_mov_b32 s46, 138412032
    s_mov_b32 s47, 0x20000
    s_lshl_b32 s54, s77, 12
    buffer_load_dwordx4 v[52:55], v1, s[40:43], s54 offen offset:0 nt
    buffer_load_dwordx4 v[56:59], v1, s[40:43], s54 offen offset:1024 nt
    buffer_load_dwordx4 v[60:63], v1, s[40:43], s54 offen offset:2048 nt
    buffer_load_dwordx4 v[64:67], v1, s[40:43], s54 offen offset:3072 nt
    buffer_load_dwordx4 v[68:71], v2, s[44:47], s54 offen offset:0 nt
    buffer_load_dwordx4 v[72:75], v2, s[44:47], s54 offen offset:256 nt
    buffer_load_dwordx4 v[76:79], v2, s[44:47], s54 offen offset:512 nt
    buffer_load_dwordx4 v[80:83], v2, s[44:47], s54 offen offset:768 nt
    s_add_u32 s58, s77, 4
    s_lshl_b32 s54, s58, 12
    s_barrier
    buffer_load_dwordx4 v[84:87], v1, s[40:43], s54 offen offset:0 nt
    buffer_load_dwordx4 v[88:91], v1, s[40:43], s54 offen offset:1024 nt
    buffer_load_dwordx4 v[92:95], v1, s[40:43], s54 offen offset:2048 nt
    buffer_load_dwordx4 v[96:99], v1, s[40:43], s54 offen offset:3072 nt
    buffer_load_dwordx4 v[100:103], v2, s[44:47], s54 offen offset:0 nt
    buffer_load_dwordx4 v[104:107], v2, s[44:47], s54 offen offset:256 nt
    buffer_load_dwordx4 v[108:111], v2, s[44:47], s54 offen offset:512 nt
    buffer_load_dwordx4 v[112:115], v2, s[44:47], s54 offen offset:768 nt
    s_mul_i32 s55, s3, 32768
    s_add_u32 m0, s55, 30208
    v_lshlrev_b32 v34, 4, v0
    v_add_u32 v34, m0, v34
    s_add_u32 s58, s77, 8
    s_lshl_b32 s54, s58, 12
    s_waitcnt vmcnt(6)
    buffer_load_dwordx4 v1, s[40:43], s54 offen offset:0 nt lds
    buffer_load_dwordx4 v1, s[40:43], s54 offen offset:1024 nt lds
    buffer_load_dwordx4 v1, s[40:43], s54 offen offset:2048 nt lds
    buffer_load_dwordx4 v1, s[40:43], s54 offen offset:3072 nt lds
    s_add_u32 m0, m0, 4096
    s_waitcnt vmcnt(6)
    buffer_load_dwordx4 v2, s[44:47], s54 offen offset:0 nt lds
    s_add_u32 m0, m0, 768
    s_nop 0
    buffer_load_dwordx4 v2, s[44:47], s54 offen offset:256 nt lds
    s_add_u32 m0, m0, 768
    s_nop 0
    buffer_load_dwordx4 v2, s[44:47], s54 offen offset:512 nt lds
    s_add_u32 m0, m0, 768
    s_nop 0
    buffer_load_dwordx4 v2, s[44:47], s54 offen offset:768 nt lds
    s_add_u32 m0, m0, 1792
    s_add_u32 s58, s77, 12
    s_lshl_b32 s54, s58, 12
    s_waitcnt vmcnt(6)
    buffer_load_dwordx4 v1, s[40:43], s54 offen offset:0 nt lds
    buffer_load_dwordx4 v1, s[40:43], s54 offen offset:1024 nt lds
    buffer_load_dwordx4 v1, s[40:43], s54 offen offset:2048 nt lds
    buffer_load_dwordx4 v1, s[40:43], s54 offen offset:3072 nt lds
    s_add_u32 m0, m0, 4096
    s_waitcnt vmcnt(6)
    buffer_load_dwordx4 v2, s[44:47], s54 offen offset:0 nt lds
    s_add_u32 m0, m0, 768
    s_nop 0
    buffer_load_dwordx4 v2, s[44:47], s54 offen offset:256 nt lds
    s_add_u32 m0, m0, 768
    s_nop 0
    buffer_load_dwordx4 v2, s[44:47], s54 offen offset:512 nt lds
    s_add_u32 m0, m0, 768
    s_nop 0
    buffer_load_dwordx4 v2, s[44:47], s54 offen offset:768 nt lds
    s_add_u32 m0, m0, 1792
    s_add_u32 s58, s77, 16
    s_lshl_b32 s54, s58, 12
    s_waitcnt vmcnt(6)
    buffer_load_dwordx4 v1, s[40:43], s54 offen offset:0 nt lds
    buffer_load_dwordx4 v1, s[40:43], s54 offen offset:1024 nt lds
    buffer_load_dwordx4 v1, s[40:43], s54 offen offset:2048 nt lds
    buffer_load_dwordx4 v1, s[40:43], s54 offen offset:3072 nt lds
    s_add_u32 m0, m0, 4096
    s_waitcnt vmcnt(6)
    buffer_load_dwordx4 v2, s[44:47], s54 offen offset:0 nt lds
    s_add_u32 m0, m0, 768
    s_nop 0
    buffer_load_dwordx4 v2, s[44:47], s54 offen offset:256 nt lds
    s_add_u32 m0, m0, 768
    s_nop 0
    buffer_load_dwordx4 v2, s[44:47], s54 offen offset:512 nt lds
    s_add_u32 m0, m0, 768
    s_nop 0
    buffer_load_dwordx4 v2, s[44:47], s54 offen offset:768 nt lds
    s_add_u32 m0, m0, 1792
    s_add_u32 s58, s77, 20
    s_lshl_b32 s54, s58, 12
    s_waitcnt vmcnt(6)
    buffer_load_dwordx4 v1, s[40:43], s54 offen offset:0 nt lds
    buffer_load_dwordx4 v1, s[40:43], s54 offen offset:1024 nt lds
    buffer_load_dwordx4 v1, s[40:43], s54 offen offset:2048 nt lds
    buffer_load_dwordx4 v1, s[40:43], s54 offen offset:3072 nt lds
    s_add_u32 m0, m0, 4096
    s_waitcnt vmcnt(6)
    buffer_load_dwordx4 v2, s[44:47], s54 offen offset:0 nt lds
    s_add_u32 m0, m0, 768
    s_nop 0
    buffer_load_dwordx4 v2, s[44:47], s54 offen offset:256 nt lds
    s_add_u32 m0, m0, 768
    s_nop 0
    buffer_load_dwordx4 v2, s[44:47], s54 offen offset:512 nt lds
    s_add_u32 m0, m0, 768
    s_nop 0
    buffer_load_dwordx4 v2, s[44:47], s54 offen offset:768 nt lds
    s_add_u32 m0, m0, 1792
    s_mov_b32 s50, 6
    s_mov_b32 s51, 2
    s_mov_b32 s52, 0
    s_mov_b32 s79, 1
    s_mov_b32 s56, 0
    s_mov_b32 s57, 5
    s_mul_i32 s55, s4, 512
    s_add_u32 s55, s55, 4194304
    s_add_u32 s48, s38, s55
    s_addc_u32 s49, s39, 0
    s_mov_b32 s60, 0xf000f
    s_mov_b32 s61, s60
    s_mov_b32 s62, 0xf000f0
    s_mov_b32 s63, s62
    s_mov_b32 s64, 0xf000f00
    s_mov_b32 s65, s64
    s_mov_b32 s66, 0xf000f000
    s_mov_b32 s67, s66
    s_mov_b32 s72, s24
    s_mov_b32 s73, s25
    s_mov_b32 s74, 5242880
    s_mov_b32 s75, 0x20000
    s_mul_i32 s76, s4, 163840
    s_lshl_b32 s55, s5, 8
    s_add_u32 s76, s76, s55
    s_mul_i32 s55, s3, 40960
    s_add_u32 s76, s76, s55
    v_mul_u32_u24 v35, 1280, v5
    v_lshl_add_u32 v35, v7, 4, v35
    s_mul_i32 s55, s3, 32768
    s_add_u32 m0, s55, 30208
    v_and_b32 v50, 1, v7
    v_lshlrev_b32 v50, 4, v50
    v_mov_b32 v51, 0xffff
    v_lshlrev_b32 v50, v50, v51
    v_lshrrev_b32 v51, 1, v7
    v_cmp_eq_u32 vcc, 0, v51
    s_nop 1
    v_cndmask_b32 v36, 0, v50, vcc
    v_cmp_eq_u32 vcc, 1, v51
    s_nop 1
    v_cndmask_b32 v37, 0, v50, vcc
    v_cmp_eq_u32 vcc, 2, v51
    s_nop 1
    v_cndmask_b32 v38, 0, v50, vcc
    v_cmp_eq_u32 vcc, 3, v51
    s_nop 1
    v_cndmask_b32 v39, 0, v50, vcc
    v_lshl_add_u32 v49, v5, 2, v6
    v_lshlrev_b32 v49, 4, v49
    v_add_u32 v49, 0, v49
    v_and_b32 v32, 1, v5
    v_lshlrev_b32 v32, 4, v32
    v_lshl_add_u32 v32, v7, 5, v32
    s_lshl_b32 s55, s3, 9
    s_add_u32 s55, s55, 1280
    v_add_u32 v32, s55, v32
    s_lshl_b32 s55, s3, 2
    s_add_u32 s55, s55, 3328
    v_mov_b32 v33, s55
    v_mov_b32 v50, 0
    v_mov_b32 v51, 0
    v_mov_b32 v247, 0
    v_mov_b32 v248, 1
    v_mov_b32 v249, 0
    s_mov_b32 s80, 0
    s_barrier
    s_branch L_build
L_loop:
    s_cmp_eq_u32 s51, 34
    s_cbranch_scc1 L_flush
L_resume:
L_top0:
    s_waitcnt vmcnt(12)
    s_cmp_lt_u32 s51, 51
    s_cbranch_scc1 L_nq0
    s_cmp_lg_u32 s56, 0
    s_cbranch_scc1 L_nq0
    s_mov_b64 exec, 1
    v_lshlrev_b32 v51, 2, v50
    ds_read_b32 v247, v51 offset:5696
    ds_add_rtn_u32 v50, v249, v248 offset:5632
    s_mov_b64 exec, -1
L_nq0:
    v_mfma_f32_16x16x32_bf16 v[12:15], v[16:19], v[52:55], 0
    v_mfma_f32_16x16x32_bf16 v[12:15], v[20:23], v[56:59], v[12:15]
    v_mfma_f32_16x16x32_bf16 v[12:15], v[24:27], v[60:63], v[12:15]
    v_mfma_f32_16x16x32_bf16 v[12:15], v[28:31], v[64:67], v[12:15]
    s_cmp_eq_u32 s50, 32
    s_cselect_b32 s77, s78, s77
    s_lshl_b32 s58, s50, 2
    s_add_u32 s58, s58, s77
    s_nop 3
    v_mov_b32_dpp v5, v12 quad_perm:[0,0,0,0] row_mask:0xf bank_mask:0xf
    v_mov_b32_dpp v6, v14 quad_perm:[2,2,2,2] row_mask:0xf bank_mask:0xf
    s_nop 0
    v_add_f32_dpp v5, v13, v5 quad_perm:[1,1,1,1] row_mask:0xf bank_mask:0xf
    v_add_f32_dpp v6, v15, v6 quad_perm:[3,3,3,3] row_mask:0xf bank_mask:0xf
    v_add_f32 v5, v5, v6
    v_cvt_pk_bf16_f32 v5, v5, v5
    v_and_b32 v5, 0xffff0000, v5
    v_mul_f32 v5, 0x3db504f3, v5
    v_cvt_pk_bf16_f32 v5, v5, v5
    v_and_b32 v5, 0xffff0000, v5
    v_mul_f32 v5, 0x3fb8aa3b, v5
    v_cmp_gt_f32 vcc, v5, v3
    s_cbranch_vccnz L_upd0
L_back0:
    v_sub_f32 v5, v5, v3
    v_exp_f32 v5, v5
    s_nop 0
    v_cvt_pk_bf16_f32 v48, v5, v5
    v_add_f32 v4, v4, v5
L_rb0:
    s_waitcnt lgkmcnt(0)
    v_readfirstlane_b32 s52, v247
    s_cmp_ge_u32 s51, 52
    s_cselect_b32 s81, s52, 0
    s_cmp_eq_u32 s81, -1
    s_cbranch_scc1 L_rt0
    s_add_u32 s53, s52, 1664
    s_cmp_lt_u32 s51, 52
    s_cselect_b32 s53, s58, s53
    s_add_u32 s50, s50, 1
    s_add_u32 s51, s51, 1
    s_lshr_b32 s55, s53, 10
    s_lshl_b32 s55, s55, 27
    s_and_b32 s58, s53, 1023
    s_lshl_b32 s54, s58, 12
    s_add_u32 s54, s54, s55
    s_cmp_ge_u32 s53, 2048
    s_addc_u32 s56, s56, 0
    s_waitcnt vmcnt(8)
    v_and_b32_dpp v40, v48, v36 row_newbcast:0 row_mask:0xf bank_mask:0xf
    v_and_b32_dpp v41, v48, v37 row_newbcast:0 row_mask:0xf bank_mask:0xf
    v_and_b32_dpp v42, v48, v38 row_newbcast:0 row_mask:0xf bank_mask:0xf
    v_and_b32_dpp v43, v48, v39 row_newbcast:0 row_mask:0xf bank_mask:0xf
    v_and_b32_dpp v44, v48, v36 row_newbcast:4 row_mask:0xf bank_mask:0xf
    v_and_b32_dpp v45, v48, v37 row_newbcast:4 row_mask:0xf bank_mask:0xf
    v_and_b32_dpp v46, v48, v38 row_newbcast:4 row_mask:0xf bank_mask:0xf
    v_and_b32_dpp v47, v48, v39 row_newbcast:4 row_mask:0xf bank_mask:0xf
    v_mfma_f32_16x16x32_bf16 v[8:11], v[40:43], v[68:71], v[8:11]
    v_and_b32_dpp v40, v48, v36 row_newbcast:8 row_mask:0xf bank_mask:0xf
    v_and_b32_dpp v41, v48, v37 row_newbcast:8 row_mask:0xf bank_mask:0xf
    v_and_b32_dpp v42, v48, v38 row_newbcast:8 row_mask:0xf bank_mask:0xf
    v_and_b32_dpp v43, v48, v39 row_newbcast:8 row_mask:0xf bank_mask:0xf
    v_mfma_f32_16x16x32_bf16 v[8:11], v[44:47], v[72:75], v[8:11]
    v_and_b32_dpp v44, v48, v36 row_newbcast:12 row_mask:0xf bank_mask:0xf
    v_and_b32_dpp v45, v48, v37 row_newbcast:12 row_mask:0xf bank_mask:0xf
    v_and_b32_dpp v46, v48, v38 row_newbcast:12 row_mask:0xf bank_mask:0xf
    v_and_b32_dpp v47, v48, v39 row_newbcast:12 row_mask:0xf bank_mask:0xf
    v_mfma_f32_16x16x32_bf16 v[8:11], v[40:43], v[76:79], v[8:11]
    s_nop 0
    v_mfma_f32_16x16x32_bf16 v[8:11], v[44:47], v[80:83], v[8:11]
L_skip0:
    s_cmp_lg_u32 s56, 0
    s_cbranch_scc1 L_dr1
    s_cmp_eq_u32 s51, s57
    s_cbranch_scc1 L_lds0
    buffer_load_dwordx4 v[52:55], v1, s[40:43], s54 offen offset:0 nt
    buffer_load_dwordx4 v[56:59], v1, s[40:43], s54 offen offset:1024 nt
    buffer_load_dwordx4 v[60:63], v1, s[40:43], s54 offen offset:2048 nt
    buffer_load_dwordx4 v[64:67], v1, s[40:43], s54 offen offset:3072 nt
    buffer_load_dwordx4 v[68:71], v2, s[44:47], s54 offen offset:0 nt
    buffer_load_dwordx4 v[72:75], v2, s[44:47], s54 offen offset:256 nt
    buffer_load_dwordx4 v[76:79], v2, s[44:47], s54 offen offset:512 nt
    buffer_load_dwordx4 v[80:83], v2, s[44:47], s54 offen offset:768 nt
L_top1:
    s_waitcnt vmcnt(12)
    s_cmp_lt_u32 s51, 51
    s_cbranch_scc1 L_nq1
    s_cmp_lg_u32 s56, 0
    s_cbranch_scc1 L_nq1
    s_mov_b64 exec, 1
    v_lshlrev_b32 v51, 2, v50
    ds_read_b32 v247, v51 offset:5696
    ds_add_rtn_u32 v50, v249, v248 offset:5632
    s_mov_b64 exec, -1
L_nq1:
    v_mfma_f32_16x16x32_bf16 v[12:15], v[16:19], v[84:87], 0
    v_mfma_f32_16x16x32_bf16 v[12:15], v[20:23], v[88:91], v[12:15]
    v_mfma_f32_16x16x32_bf16 v[12:15], v[24:27], v[92:95], v[12:15]
    v_mfma_f32_16x16x32_bf16 v[12:15], v[28:31], v[96:99], v[12:15]
    s_cmp_eq_u32 s50, 32
    s_cselect_b32 s77, s78, s77
    s_lshl_b32 s58, s50, 2
    s_add_u32 s58, s58, s77
    s_nop 3
    v_mov_b32_dpp v5, v12 quad_perm:[0,0,0,0] row_mask:0xf bank_mask:0xf
    v_mov_b32_dpp v6, v14 quad_perm:[2,2,2,2] row_mask:0xf bank_mask:0xf
    s_nop 0
    v_add_f32_dpp v5, v13, v5 quad_perm:[1,1,1,1] row_mask:0xf bank_mask:0xf
    v_add_f32_dpp v6, v15, v6 quad_perm:[3,3,3,3] row_mask:0xf bank_mask:0xf
    v_add_f32 v5, v5, v6
    v_cvt_pk_bf16_f32 v5, v5, v5
    v_and_b32 v5, 0xffff0000, v5
    v_mul_f32 v5, 0x3db504f3, v5
    v_cvt_pk_bf16_f32 v5, v5, v5
    v_and_b32 v5, 0xffff0000, v5
    v_mul_f32 v5, 0x3fb8aa3b, v5
    v_cmp_gt_f32 vcc, v5, v3
    s_cbranch_vccnz L_upd1
L_back1:
    v_sub_f32 v5, v5, v3
    v_exp_f32 v5, v5
    s_nop 0
    v_cvt_pk_bf16_f32 v48, v5, v5
    v_add_f32 v4, v4, v5
L_rb1:
    s_waitcnt lgkmcnt(0)
    v_readfirstlane_b32 s52, v247
    s_cmp_ge_u32 s51, 52
    s_cselect_b32 s81, s52, 0
    s_cmp_eq_u32 s81, -1
    s_cbranch_scc1 L_rt1
    s_add_u32 s53, s52, 1664
    s_cmp_lt_u32 s51, 52
    s_cselect_b32 s53, s58, s53
    s_add_u32 s50, s50, 1
    s_add_u32 s51, s51, 1
    s_lshr_b32 s55, s53, 10
    s_lshl_b32 s55, s55, 27
    s_and_b32 s58, s53, 1023
    s_lshl_b32 s54, s58, 12
    s_add_u32 s54, s54, s55
    s_cmp_ge_u32 s53, 2048
    s_addc_u32 s56, s56, 0
    s_waitcnt vmcnt(8)
    v_and_b32_dpp v40, v48, v36 row_newbcast:0 row_mask:0xf bank_mask:0xf
    v_and_b32_dpp v41, v48, v37 row_newbcast:0 row_mask:0xf bank_mask:0xf
    v_and_b32_dpp v42, v48, v38 row_newbcast:0 row_mask:0xf bank_mask:0xf
    v_and_b32_dpp v43, v48, v39 row_newbcast:0 row_mask:0xf bank_mask:0xf
    v_and_b32_dpp v44, v48, v36 row_newbcast:4 row_mask:0xf bank_mask:0xf
    v_and_b32_dpp v45, v48, v37 row_newbcast:4 row_mask:0xf bank_mask:0xf
    v_and_b32_dpp v46, v48, v38 row_newbcast:4 row_mask:0xf bank_mask:0xf
    v_and_b32_dpp v47, v48, v39 row_newbcast:4 row_mask:0xf bank_mask:0xf
    v_mfma_f32_16x16x32_bf16 v[8:11], v[40:43], v[100:103], v[8:11]
    v_and_b32_dpp v40, v48, v36 row_newbcast:8 row_mask:0xf bank_mask:0xf
    v_and_b32_dpp v41, v48, v37 row_newbcast:8 row_mask:0xf bank_mask:0xf
    v_and_b32_dpp v42, v48, v38 row_newbcast:8 row_mask:0xf bank_mask:0xf
    v_and_b32_dpp v43, v48, v39 row_newbcast:8 row_mask:0xf bank_mask:0xf
    v_mfma_f32_16x16x32_bf16 v[8:11], v[44:47], v[104:107], v[8:11]
    v_and_b32_dpp v44, v48, v36 row_newbcast:12 row_mask:0xf bank_mask:0xf
    v_and_b32_dpp v45, v48, v37 row_newbcast:12 row_mask:0xf bank_mask:0xf
    v_and_b32_dpp v46, v48, v38 row_newbcast:12 row_mask:0xf bank_mask:0xf
    v_and_b32_dpp v47, v48, v39 row_newbcast:12 row_mask:0xf bank_mask:0xf
    v_mfma_f32_16x16x32_bf16 v[8:11], v[40:43], v[108:111], v[8:11]
    s_nop 0
    v_mfma_f32_16x16x32_bf16 v[8:11], v[44:47], v[112:115], v[8:11]
L_skip1:
    s_cmp_lg_u32 s56, 0
    s_cbranch_scc1 L_dr0
    s_cmp_eq_u32 s51, s57
    s_cbranch_scc1 L_lds1
    buffer_load_dwordx4 v[84:87], v1, s[40:43], s54 offen offset:0 nt
    buffer_load_dwordx4 v[88:91], v1, s[40:43], s54 offen offset:1024 nt
    buffer_load_dwordx4 v[92:95], v1, s[40:43], s54 offen offset:2048 nt
    buffer_load_dwordx4 v[96:99], v1, s[40:43], s54 offen offset:3072 nt
    buffer_load_dwordx4 v[100:103], v2, s[44:47], s54 offen offset:0 nt
    buffer_load_dwordx4 v[104:107], v2, s[44:47], s54 offen offset:256 nt
    buffer_load_dwordx4 v[108:111], v2, s[44:47], s54 offen offset:512 nt
    buffer_load_dwordx4 v[112:115], v2, s[44:47], s54 offen offset:768 nt
    s_branch L_loop
L_rt0:
    s_sleep 1
    ds_read_b32 v247, v51 offset:5696
    s_branch L_rb0
L_rt1:
    s_sleep 1
    ds_read_b32 v247, v51 offset:5696
    s_branch L_rb1
L_lds0:
    ds_read_b128 v[52:55], v34 offset:0
    ds_read_b128 v[56:59], v34 offset:1024
    ds_read_b128 v[60:63], v34 offset:2048
    ds_read_b128 v[64:67], v34 offset:3072
    ds_read_b128 v[68:71], v34 offset:4096
    ds_read_b128 v[72:75], v34 offset:5120
    ds_read_b128 v[76:79], v34 offset:6144
    ds_read_b128 v[80:83], v34 offset:7168
    v_add_u32 v34, 8192, v34
L_xb0:
    s_sub_u32 s50, s50, 1
    s_add_u32 s57, s57, 2
    s_cmp_eq_u32 s57, 13
    s_cselect_b32 s57, 0, s57
    s_waitcnt lgkmcnt(0)
    s_branch L_top0
L_lds1:
    ds_read_b128 v[84:87], v34 offset:0
    ds_read_b128 v[88:91], v34 offset:1024
    ds_read_b128 v[92:95], v34 offset:2048
    ds_read_b128 v[96:99], v34 offset:3072
    ds_read_b128 v[100:103], v34 offset:4096
    ds_read_b128 v[104:107], v34 offset:5120
    ds_read_b128 v[108:111], v34 offset:6144
    ds_read_b128 v[112:115], v34 offset:7168
    v_add_u32 v34, 8192, v34
L_xb1:
    s_sub_u32 s50, s50, 1
    s_add_u32 s57, s57, 2
    s_cmp_eq_u32 s57, 13
    s_cselect_b32 s57, 0, s57
    s_waitcnt lgkmcnt(0)
    s_branch L_top1
L_dw0:
    s_cmp_eq_u32 s56, 2
    s_cbranch_scc1 L_flush
    s_cmp_eq_u32 s56, 1
    s_cbranch_scc1 L_wo0
    s_branch L_flush
L_wo0:
    buffer_load_dwordx4 v35, s[72:75], s76 offen nt lds
    s_add_u32 m0, m0, 1024
    s_add_u32 s76, s76, 5120
    buffer_load_dwordx4 v35, s[72:75], s76 offen nt lds
    s_add_u32 m0, m0, 1024
    s_add_u32 s76, s76, 5120
    buffer_load_dwordx4 v35, s[72:75], s76 offen nt lds
    s_add_u32 m0, m0, 1024
    s_add_u32 s76, s76, 5120
    buffer_load_dwordx4 v35, s[72:75], s76 offen nt lds
    s_add_u32 m0, m0, 1024
    s_add_u32 s76, s76, 5120
    buffer_load_dwordx4 v35, s[72:75], s76 offen nt lds
    s_add_u32 m0, m0, 1024
    s_add_u32 s76, s76, 5120
    buffer_load_dwordx4 v35, s[72:75], s76 offen nt lds
    s_add_u32 m0, m0, 1024
    s_add_u32 s76, s76, 5120
    buffer_load_dwordx4 v35, s[72:75], s76 offen nt lds
    s_add_u32 m0, m0, 1024
    s_add_u32 s76, s76, 5120
    buffer_load_dwordx4 v35, s[72:75], s76 offen nt lds
    s_branch L_top0
L_dw1:
    s_cmp_eq_u32 s56, 2
    s_cbranch_scc1 L_flush
    s_cmp_eq_u32 s56, 1
    s_cbranch_scc1 L_wo1
    s_branch L_flush
L_wo1:
    buffer_load_dwordx4 v35, s[72:75], s76 offen nt lds
    s_add_u32 m0, m0, 1024
    s_add_u32 s76, s76, 5120
    buffer_load_dwordx4 v35, s[72:75], s76 offen nt lds
    s_add_u32 m0, m0, 1024
    s_add_u32 s76, s76, 5120
    buffer_load_dwordx4 v35, s[72:75], s76 offen nt lds
    s_add_u32 m0, m0, 1024
    s_add_u32 s76, s76, 5120
    buffer_load_dwordx4 v35, s[72:75], s76 offen nt lds
    s_add_u32 m0, m0, 1024
    s_add_u32 s76, s76, 5120
    buffer_load_dwordx4 v35, s[72:75], s76 offen nt lds
    s_add_u32 m0, m0, 1024
    s_add_u32 s76, s76, 5120
    buffer_load_dwordx4 v35, s[72:75], s76 offen nt lds
    s_add_u32 m0, m0, 1024
    s_add_u32 s76, s76, 5120
    buffer_load_dwordx4 v35, s[72:75], s76 offen nt lds
    s_add_u32 m0, m0, 1024
    s_add_u32 s76, s76, 5120
    buffer_load_dwordx4 v35, s[72:75], s76 offen nt lds
    s_branch L_top1
L_dr0:
    s_cmp_lt_u32 s5, 5
    s_cbranch_scc1 L_dw0
    s_waitcnt vmcnt(0)
    s_cmp_eq_u32 s56, 1
    s_cbranch_scc1 L_top0
    s_branch L_flush
L_dr1:
    s_cmp_lt_u32 s5, 5
    s_cbranch_scc1 L_dw1
    s_waitcnt vmcnt(0)
    s_cmp_eq_u32 s56, 1
    s_cbranch_scc1 L_top1
L_flush:
    s_nop 1
    v_add_f32_dpp v4, v4, v4 row_ror:4 row_mask:0xf bank_mask:0xf
    s_nop 1
    v_add_f32_dpp v4, v4, v4 row_ror:8 row_mask:0xf bank_mask:0xf
    v_mov_b32 v5, v4
    s_nop 1
    v_permlane16_swap_b32 v4, v5
    v_add_f32 v4, v4, v5
    v_mov_b32 v5, v4
    s_nop 1
    v_permlane32_swap_b32 v4, v5
    v_add_f32 v4, v4, v5
    s_mov_b32 exec_hi, 0
    ds_write_b128 v32, v[8:11]
    ds_write2_b32 v33, v3, v4 offset0:0 offset1:4
    s_mov_b64 exec, -1
    s_cmp_eq_u32 s56, 2
    s_cbranch_scc1 L_sdone
    v_add_u32 v32, 2176, v32
    v_add_u32 v33, 2176, v33
    v_add_u32 v49, 256, v49
L_build:
    ds_read_b128 v[40:43], v49
    v_mov_b32 v3, 0xff800000
    v_mov_b32 v4, 0
    v_mov_b32 v8, 0
    v_mov_b32 v9, 0
    v_mov_b32 v10, 0
    v_mov_b32 v11, 0
    s_waitcnt lgkmcnt(0)
    v_cndmask_b32 v16, 0, v40, s[60:61]
    v_cndmask_b32 v17, 0, v41, s[60:61]
    v_cndmask_b32 v18, 0, v42, s[60:61]
    v_cndmask_b32 v19, 0, v43, s[60:61]
    v_cndmask_b32 v20, 0, v40, s[62:63]
    v_cndmask_b32 v21, 0, v41, s[62:63]
    v_cndmask_b32 v22, 0, v42, s[62:63]
    v_cndmask_b32 v23, 0, v43, s[62:63]
    v_cndmask_b32 v24, 0, v40, s[64:65]
    v_cndmask_b32 v25, 0, v41, s[64:65]
    v_cndmask_b32 v26, 0, v42, s[64:65]
    v_cndmask_b32 v27, 0, v43, s[64:65]
    v_cndmask_b32 v28, 0, v40, s[66:67]
    v_cndmask_b32 v29, 0, v41, s[66:67]
    v_cndmask_b32 v30, 0, v42, s[66:67]
    v_cndmask_b32 v31, 0, v43, s[66:67]
    s_cmp_eq_u32 s51, 2
    s_nop 0
    s_cbranch_scc1 L_loop
    s_branch L_resume
L_upd0:
    s_nop 1
    v_max_f32_dpp v6, v5, v5 row_ror:4 row_mask:0xf bank_mask:0xf
    s_nop 1
    v_max_f32_dpp v6, v6, v6 row_ror:8 row_mask:0xf bank_mask:0xf
    s_nop 0
    v_readlane_b32 s68, v6, 0
    v_readlane_b32 s69, v6, 16
    v_readlane_b32 s70, v6, 32
    v_readlane_b32 s71, v6, 48
    v_max_f32 v6, s68, v3
    v_max_f32 v6, s69, v6
    v_max_f32 v6, s70, v6
    v_max_f32 v6, s71, v6
    v_sub_f32 v7, v3, v6
    v_exp_f32 v7, v7
    v_mov_b32 v3, v6
    v_mul_f32 v4, v4, v7
    v_mul_f32 v8, v8, v7
    v_mul_f32 v9, v9, v7
    v_mul_f32 v10, v10, v7
    v_mul_f32 v11, v11, v7
    s_branch L_back0
L_upd1:
    s_nop 1
    v_max_f32_dpp v6, v5, v5 row_ror:4 row_mask:0xf bank_mask:0xf
    s_nop 1
    v_max_f32_dpp v6, v6, v6 row_ror:8 row_mask:0xf bank_mask:0xf
    s_nop 0
    v_readlane_b32 s68, v6, 0
    v_readlane_b32 s69, v6, 16
    v_readlane_b32 s70, v6, 32
    v_readlane_b32 s71, v6, 48
    v_max_f32 v6, s68, v3
    v_max_f32 v6, s69, v6
    v_max_f32 v6, s70, v6
    v_max_f32 v6, s71, v6
    v_sub_f32 v7, v3, v6
    v_exp_f32 v7, v7
    v_mov_b32 v3, v6
    v_mul_f32 v4, v4, v7
    v_mul_f32 v8, v8, v7
    v_mul_f32 v9, v9, v7
    v_mul_f32 v10, v10, v7
    v_mul_f32 v11, v11, v7
    s_branch L_back1
L_sdone:
    s_waitcnt lgkmcnt(0)
    s_barrier
    s_cmp_ge_u32 s5, 5
    s_cbranch_scc1 L_sd3
    s_waitcnt vmcnt(0)
    s_barrier
L_sd3:
    s_waitcnt vmcnt(0)
    s_endpgm
L_service:
    s_setprio 3
    v_lshrrev_b32 v5, 4, v0
    v_and_b32 v4, 15, v0
    v_lshlrev_b32 v147, 4, v0
    s_cmp_ge_u32 s3, 6
    s_cbranch_scc1 L_w67
    s_cmp_ge_u32 s4, 27
    s_cselect_b32 s6, 5, 0
    s_cmp_eq_u32 s3, s6
    s_cbranch_scc1 L_end
    v_bfe_u32 v6, v0, 3, 1
    v_mul_u32_u24 v6, 1280, v6
    v_and_b32 v3, 7, v0
    v_lshl_add_u32 v1, v5, 3, v3
    v_lshl_add_u32 v1, v1, 3, v6
    s_mul_i32 s9, s5, 80
    v_mul_u32_u24 v148, 20, v5
    v_add_u32 v148, s9, v148
    v_lshl_add_u32 v2, v148, 1, v6
    s_cmp_eq_u32 s3, 5
    s_cbranch_scc1 L_ld5
    s_lshl_b32 s10, s4, 8
    v_lshlrev_b32 v149, 13, v148
    v_lshl_add_u32 v149, v4, 4, v149
    s_waitcnt lgkmcnt(0)
    s_mov_b32 s40, s16
    s_mov_b32 s41, s17
    s_mov_b32 s42, 2560
    s_mov_b32 s43, 0x20000
    s_mov_b32 s44, s22
    s_mov_b32 s45, s23
    s_mov_b32 s46, 5242880
    s_mov_b32 s47, 0x20000
    buffer_load_dwordx2 v[8:9], v1, s[40:43], 0 offen offset:0
    buffer_load_dwordx2 v[10:11], v1, s[40:43], 0 offen offset:256
    buffer_load_dwordx2 v[12:13], v1, s[40:43], 0 offen offset:512
    buffer_load_dwordx2 v[14:15], v1, s[40:43], 0 offen offset:768
    buffer_load_dwordx2 v[16:17], v1, s[40:43], 0 offen offset:1024
    buffer_load_dwordx4 v[18:21], v2, s[40:43], 0 offen
    buffer_load_dwordx4 v[22:25], v2, s[40:43], 0 offen offset:16
    buffer_load_dwordx2 v[26:27], v2, s[40:43], 0 offen offset:32
    buffer_load_dwordx4 v[28:31], v149, s[44:47], s10 offen nt
    s_add_u32 s10, s10, 8192
    buffer_load_dwordx4 v[32:35], v149, s[44:47], s10 offen nt
    s_add_u32 s10, s10, 8192
    buffer_load_dwordx4 v[36:39], v149, s[44:47], s10 offen nt
    s_add_u32 s10, s10, 8192
    buffer_load_dwordx4 v[40:43], v149, s[44:47], s10 offen nt
    s_add_u32 s10, s10, 8192
    buffer_load_dwordx4 v[44:47], v149, s[44:47], s10 offen nt
    s_add_u32 s10, s10, 8192
    buffer_load_dwordx4 v[48:51], v149, s[44:47], s10 offen nt
    s_add_u32 s10, s10, 8192
    buffer_load_dwordx4 v[52:55], v149, s[44:47], s10 offen nt
    s_add_u32 s10, s10, 8192
    buffer_load_dwordx4 v[56:59], v149, s[44:47], s10 offen nt
    s_add_u32 s10, s10, 8192
    buffer_load_dwordx4 v[60:63], v149, s[44:47], s10 offen nt
    s_add_u32 s10, s10, 8192
    buffer_load_dwordx4 v[64:67], v149, s[44:47], s10 offen nt
    s_add_u32 s10, s10, 8192
    buffer_load_dwordx4 v[68:71], v149, s[44:47], s10 offen nt
    s_add_u32 s10, s10, 8192
    buffer_load_dwordx4 v[72:75], v149, s[44:47], s10 offen nt
    s_add_u32 s10, s10, 8192
    buffer_load_dwordx4 v[76:79], v149, s[44:47], s10 offen nt
    s_add_u32 s10, s10, 8192
    buffer_load_dwordx4 v[80:83], v149, s[44:47], s10 offen nt
    s_add_u32 s10, s10, 8192
    buffer_load_dwordx4 v[84:87], v149, s[44:47], s10 offen nt
    s_add_u32 s10, s10, 8192
    buffer_load_dwordx4 v[88:91], v149, s[44:47], s10 offen nt
    s_add_u32 s10, s10, 8192
    buffer_load_dwordx4 v[92:95], v149, s[44:47], s10 offen nt
    s_add_u32 s10, s10, 8192
    buffer_load_dwordx4 v[96:99], v149, s[44:47], s10 offen nt
    s_add_u32 s10, s10, 8192
    buffer_load_dwordx4 v[100:103], v149, s[44:47], s10 offen nt
    s_add_u32 s10, s10, 8192
    buffer_load_dwordx4 v[104:107], v149, s[44:47], s10 offen nt
    s_mov_b32 s56, s38
    s_mov_b32 s57, s39
    s_mov_b32 s58, 8388608
    s_mov_b32 s59, 0x20000
    s_mul_i32 s11, s4, 512
    s_add_u32 s11, s11, 4194304
    s_barrier
    s_load_dword s87, s[38:39], 0
    s_mov_b32 s12, 262144
    s_waitcnt vmcnt(20)
    s_cmp_lg_u32 s5, 0
    s_cbranch_scc1 L_ln
    v_mov_b32 v144, 0
    v_lshlrev_b32 v145, 2, v0
    buffer_store_dword v144, v145, s[56:59], s11 offen sc1
    s_branch L_ln
L_ld5:
    s_lshl_b32 s10, s4, 7
    v_mul_u32_u24 v149, 3456, v148
    v_lshl_add_u32 v149, v3, 4, v149
    s_waitcnt lgkmcnt(0)
    s_mov_b32 s40, s16
    s_mov_b32 s41, s17
    s_mov_b32 s42, 2560
    s_mov_b32 s43, 0x20000
    s_mov_b32 s48, s28
    s_mov_b32 s49, s29
    s_mov_b32 s50, 2211840
    s_mov_b32 s51, 0x20000
    s_mov_b32 s52, s30
    s_mov_b32 s53, s31
    s_mov_b32 s54, 2211840
    s_mov_b32 s55, 0x20000
    buffer_load_dwordx2 v[8:9], v1, s[40:43], 0 offen offset:0
    buffer_load_dwordx2 v[10:11], v1, s[40:43], 0 offen offset:256
    buffer_load_dwordx2 v[12:13], v1, s[40:43], 0 offen offset:512
    buffer_load_dwordx2 v[14:15], v1, s[40:43], 0 offen offset:768
    buffer_load_dwordx2 v[16:17], v1, s[40:43], 0 offen offset:1024
    buffer_load_dwordx4 v[18:21], v2, s[40:43], 0 offen
    buffer_load_dwordx4 v[22:25], v2, s[40:43], 0 offen offset:16
    buffer_load_dwordx2 v[26:27], v2, s[40:43], 0 offen offset:32
    s_mov_b32 exec_lo, 0xff00ff
    s_mov_b32 exec_hi, 0xff00ff
    s_mov_b32 s11, s10
    buffer_load_dwordx4 v[28:31], v149, s[48:51], s11 offen nt
    s_add_u32 s11, s11, 3456
    buffer_load_dwordx4 v[32:35], v149, s[48:51], s11 offen nt
    s_add_u32 s11, s11, 3456
    buffer_load_dwordx4 v[36:39], v149, s[48:51], s11 offen nt
    s_add_u32 s11, s11, 3456
    buffer_load_dwordx4 v[40:43], v149, s[48:51], s11 offen nt
    s_add_u32 s11, s11, 3456
    buffer_load_dwordx4 v[44:47], v149, s[48:51], s11 offen nt
    s_add_u32 s11, s11, 3456
    buffer_load_dwordx4 v[48:51], v149, s[48:51], s11 offen nt
    s_add_u32 s11, s11, 3456
    buffer_load_dwordx4 v[52:55], v149, s[48:51], s11 offen nt
    s_add_u32 s11, s11, 3456
    buffer_load_dwordx4 v[56:59], v149, s[48:51], s11 offen nt
    s_add_u32 s11, s11, 3456
    buffer_load_dwordx4 v[60:63], v149, s[48:51], s11 offen nt
    s_add_u32 s11, s11, 3456
    buffer_load_dwordx4 v[64:67], v149, s[48:51], s11 offen nt
    s_add_u32 s11, s11, 3456
    buffer_load_dwordx4 v[68:71], v149, s[48:51], s11 offen nt
    s_add_u32 s11, s11, 3456
    buffer_load_dwordx4 v[72:75], v149, s[48:51], s11 offen nt
    s_add_u32 s11, s11, 3456
    buffer_load_dwordx4 v[76:79], v149, s[48:51], s11 offen nt
    s_add_u32 s11, s11, 3456
    buffer_load_dwordx4 v[80:83], v149, s[48:51], s11 offen nt
    s_add_u32 s11, s11, 3456
    buffer_load_dwordx4 v[84:87], v149, s[48:51], s11 offen nt
    s_add_u32 s11, s11, 3456
    buffer_load_dwordx4 v[88:91], v149, s[48:51], s11 offen nt
    s_add_u32 s11, s11, 3456
    buffer_load_dwordx4 v[92:95], v149, s[48:51], s11 offen nt
    s_add_u32 s11, s11, 3456
    buffer_load_dwordx4 v[96:99], v149, s[48:51], s11 offen nt
    s_add_u32 s11, s11, 3456
    buffer_load_dwordx4 v[100:103], v149, s[48:51], s11 offen nt
    s_add_u32 s11, s11, 3456
    buffer_load_dwordx4 v[104:107], v149, s[48:51], s11 offen nt
    s_mov_b32 exec_lo, 0xff00ff00
    s_mov_b32 exec_hi, 0xff00ff00
    s_mov_b32 s11, s10
    buffer_load_dwordx4 v[28:31], v149, s[52:55], s11 offen nt
    s_add_u32 s11, s11, 3456
    buffer_load_dwordx4 v[32:35], v149, s[52:55], s11 offen nt
    s_add_u32 s11, s11, 3456
    buffer_load_dwordx4 v[36:39], v149, s[52:55], s11 offen nt
    s_add_u32 s11, s11, 3456
    buffer_load_dwordx4 v[40:43], v149, s[52:55], s11 offen nt
    s_add_u32 s11, s11, 3456
    buffer_load_dwordx4 v[44:47], v149, s[52:55], s11 offen nt
    s_add_u32 s11, s11, 3456
    buffer_load_dwordx4 v[48:51], v149, s[52:55], s11 offen nt
    s_add_u32 s11, s11, 3456
    buffer_load_dwordx4 v[52:55], v149, s[52:55], s11 offen nt
    s_add_u32 s11, s11, 3456
    buffer_load_dwordx4 v[56:59], v149, s[52:55], s11 offen nt
    s_add_u32 s11, s11, 3456
    buffer_load_dwordx4 v[60:63], v149, s[52:55], s11 offen nt
    s_add_u32 s11, s11, 3456
    buffer_load_dwordx4 v[64:67], v149, s[52:55], s11 offen nt
    s_add_u32 s11, s11, 3456
    buffer_load_dwordx4 v[68:71], v149, s[52:55], s11 offen nt
    s_add_u32 s11, s11, 3456
    buffer_load_dwordx4 v[72:75], v149, s[52:55], s11 offen nt
    s_add_u32 s11, s11, 3456
    buffer_load_dwordx4 v[76:79], v149, s[52:55], s11 offen nt
    s_add_u32 s11, s11, 3456
    buffer_load_dwordx4 v[80:83], v149, s[52:55], s11 offen nt
    s_add_u32 s11, s11, 3456
    buffer_load_dwordx4 v[84:87], v149, s[52:55], s11 offen nt
    s_add_u32 s11, s11, 3456
    buffer_load_dwordx4 v[88:91], v149, s[52:55], s11 offen nt
    s_add_u32 s11, s11, 3456
    buffer_load_dwordx4 v[92:95], v149, s[52:55], s11 offen nt
    s_add_u32 s11, s11, 3456
    buffer_load_dwordx4 v[96:99], v149, s[52:55], s11 offen nt
    s_add_u32 s11, s11, 3456
    buffer_load_dwordx4 v[100:103], v149, s[52:55], s11 offen nt
    s_add_u32 s11, s11, 3456
    buffer_load_dwordx4 v[104:107], v149, s[52:55], s11 offen nt
    s_mov_b64 exec, -1
    s_barrier
    s_mov_b32 s56, s38
    s_mov_b32 s57, s39
    s_mov_b32 s58, 8388608
    s_mov_b32 s59, 0x20000
    s_load_dword s87, s[38:39], 0
    s_mov_b32 s12, 524288
    s_waitcnt vmcnt(40)
L_ln:
    v_lshlrev_b32 v108, 16, v8
    v_and_b32 v109, 0xffff0000, v8
    v_lshlrev_b32 v110, 16, v9
    v_and_b32 v111, 0xffff0000, v9
    v_lshlrev_b32 v112, 16, v10
    v_and_b32 v113, 0xffff0000, v10
    v_lshlrev_b32 v114, 16, v11
    v_and_b32 v115, 0xffff0000, v11
    v_lshlrev_b32 v116, 16, v12
    v_and_b32 v117, 0xffff0000, v12
    v_lshlrev_b32 v118, 16, v13
    v_and_b32 v119, 0xffff0000, v13
    v_lshlrev_b32 v120, 16, v14
    v_and_b32 v121, 0xffff0000, v14
    v_lshlrev_b32 v122, 16, v15
    v_and_b32 v123, 0xffff0000, v15
    v_lshlrev_b32 v124, 16, v16
    v_and_b32 v125, 0xffff0000, v16
    v_lshlrev_b32 v126, 16, v17
    v_and_b32 v127, 0xffff0000, v17
    v_pk_add_f32 v[128:129], v[108:109], v[110:111]
    v_pk_add_f32 v[130:131], v[112:113], v[114:115]
    v_pk_add_f32 v[132:133], v[116:117], v[118:119]
    v_pk_add_f32 v[134:135], v[120:121], v[122:123]
    v_pk_add_f32 v[136:137], v[124:125], v[126:127]
    v_pk_add_f32 v[128:129], v[128:129], v[130:131]
    v_pk_add_f32 v[132:133], v[132:133], v[134:135]
    v_pk_add_f32 v[128:129], v[128:129], v[136:137]
    v_pk_add_f32 v[128:129], v[128:129], v[132:133]
    v_add_f32 v128, v128, v129
    s_nop 1
    v_add_f32_dpp v128, v128, v128 quad_perm:[1,0,3,2] row_mask:0xf bank_mask:0xf
    s_nop 1
    v_add_f32_dpp v128, v128, v128 quad_perm:[2,3,0,1] row_mask:0xf bank_mask:0xf
    s_nop 1
    v_add_f32_dpp v128, v128, v128 row_half_mirror row_mask:0xf bank_mask:0xf
    v_mov_b32 v129, v128
    s_nop 1
    v_permlane16_swap_b32 v128, v129
    v_add_f32 v128, v128, v129
    v_mov_b32 v129, v128
    s_nop 1
    v_permlane32_swap_b32 v128, v129
    v_add_f32 v128, v128, v129
    v_mul_f32 v138, 0x3acccccd, v128
    v_pk_add_f32 v[108:109], v[108:109], v[138:139] op_sel_hi:[1,0] neg_lo:[0,1] neg_hi:[0,1]
    v_pk_add_f32 v[110:111], v[110:111], v[138:139] op_sel_hi:[1,0] neg_lo:[0,1] neg_hi:[0,1]
    v_pk_add_f32 v[112:113], v[112:113], v[138:139] op_sel_hi:[1,0] neg_lo:[0,1] neg_hi:[0,1]
    v_pk_add_f32 v[114:115], v[114:115], v[138:139] op_sel_hi:[1,0] neg_lo:[0,1] neg_hi:[0,1]
    v_pk_add_f32 v[116:117], v[116:117], v[138:139] op_sel_hi:[1,0] neg_lo:[0,1] neg_hi:[0,1]
    v_pk_add_f32 v[118:119], v[118:119], v[138:139] op_sel_hi:[1,0] neg_lo:[0,1] neg_hi:[0,1]
    v_pk_add_f32 v[120:121], v[120:121], v[138:139] op_sel_hi:[1,0] neg_lo:[0,1] neg_hi:[0,1]
    v_pk_add_f32 v[122:123], v[122:123], v[138:139] op_sel_hi:[1,0] neg_lo:[0,1] neg_hi:[0,1]
    v_pk_add_f32 v[124:125], v[124:125], v[138:139] op_sel_hi:[1,0] neg_lo:[0,1] neg_hi:[0,1]
    v_pk_add_f32 v[126:127], v[126:127], v[138:139] op_sel_hi:[1,0] neg_lo:[0,1] neg_hi:[0,1]
    v_pk_mul_f32 v[108:109], v[108:109], v[108:109]
    v_pk_mul_f32 v[110:111], v[110:111], v[110:111]
    v_pk_mul_f32 v[112:113], v[112:113], v[112:113]
    v_pk_mul_f32 v[114:115], v[114:115], v[114:115]
    v_pk_mul_f32 v[116:117], v[116:117], v[116:117]
    v_pk_mul_f32 v[118:119], v[118:119], v[118:119]
    v_pk_mul_f32 v[120:121], v[120:121], v[120:121]
    v_pk_mul_f32 v[122:123], v[122:123], v[122:123]
    v_pk_mul_f32 v[124:125], v[124:125], v[124:125]
    v_pk_mul_f32 v[126:127], v[126:127], v[126:127]
    v_pk_add_f32 v[128:129], v[108:109], v[110:111]
    v_pk_add_f32 v[130:131], v[112:113], v[114:115]
    v_pk_add_f32 v[132:133], v[116:117], v[118:119]
    v_pk_add_f32 v[134:135], v[120:121], v[122:123]
    v_pk_add_f32 v[136:137], v[124:125], v[126:127]
    v_pk_add_f32 v[128:129], v[128:129], v[130:131]
    v_pk_add_f32 v[132:133], v[132:133], v[134:135]
    v_pk_add_f32 v[128:129], v[128:129], v[136:137]
    v_pk_add_f32 v[128:129], v[128:129], v[132:133]
    v_add_f32 v128, v128, v129
    s_nop 1
    v_add_f32_dpp v128, v128, v128 quad_perm:[1,0,3,2] row_mask:0xf bank_mask:0xf
    s_nop 1
    v_add_f32_dpp v128, v128, v128 quad_perm:[2,3,0,1] row_mask:0xf bank_mask:0xf
    s_nop 1
    v_add_f32_dpp v128, v128, v128 row_half_mirror row_mask:0xf bank_mask:0xf
    v_mov_b32 v129, v128
    s_nop 1
    v_permlane16_swap_b32 v128, v129
    v_add_f32 v128, v128, v129
    v_mov_b32 v129, v128
    s_nop 1
    v_permlane32_swap_b32 v128, v129
    v_add_f32 v128, v128, v129
    v_mul_f32 v140, 0x3acccccd, v128
    v_cvt_pk_bf16_f32 v139, v138, v140
    v_lshlrev_b32 v138, 16, v139
    v_and_b32 v140, 0xffff0000, v139
    v_add_f32 v140, 0x3727c5ac, v140
    v_cvt_pk_bf16_f32 v140, v140, v140
    v_and_b32 v140, 0xffff0000, v140
    v_sqrt_f32 v140, v140
    v_lshlrev_b32 v108, 16, v18
    v_and_b32 v109, 0xffff0000, v18
    v_cvt_pk_bf16_f32 v140, v140, v140
    v_and_b32 v140, 0xffff0000, v140
    v_lshlrev_b32 v110, 16, v19
    v_and_b32 v111, 0xffff0000, v19
    v_rcp_f32 v140, v140
    v_lshlrev_b32 v112, 16, v20
    v_and_b32 v113, 0xffff0000, v20
    v_lshlrev_b32 v114, 16, v21
    v_and_b32 v115, 0xffff0000, v21
    v_lshlrev_b32 v116, 16, v22
    v_and_b32 v117, 0xffff0000, v22
    v_lshlrev_b32 v118, 16, v23
    v_and_b32 v119, 0xffff0000, v23
    v_lshlrev_b32 v120, 16, v24
    v_and_b32 v121, 0xffff0000, v24
    v_lshlrev_b32 v122, 16, v25
    v_and_b32 v123, 0xffff0000, v25
    v_lshlrev_b32 v124, 16, v26
    v_and_b32 v125, 0xffff0000, v26
    v_lshlrev_b32 v126, 16, v27
    v_and_b32 v127, 0xffff0000, v27
    v_pk_add_f32 v[108:109], v[108:109], v[138:139] op_sel_hi:[1,0] neg_lo:[0,1] neg_hi:[0,1]
    v_pk_add_f32 v[110:111], v[110:111], v[138:139] op_sel_hi:[1,0] neg_lo:[0,1] neg_hi:[0,1]
    v_pk_add_f32 v[112:113], v[112:113], v[138:139] op_sel_hi:[1,0] neg_lo:[0,1] neg_hi:[0,1]
    v_pk_add_f32 v[114:115], v[114:115], v[138:139] op_sel_hi:[1,0] neg_lo:[0,1] neg_hi:[0,1]
    v_pk_add_f32 v[116:117], v[116:117], v[138:139] op_sel_hi:[1,0] neg_lo:[0,1] neg_hi:[0,1]
    v_pk_add_f32 v[118:119], v[118:119], v[138:139] op_sel_hi:[1,0] neg_lo:[0,1] neg_hi:[0,1]
    v_pk_add_f32 v[120:121], v[120:121], v[138:139] op_sel_hi:[1,0] neg_lo:[0,1] neg_hi:[0,1]
    v_pk_add_f32 v[122:123], v[122:123], v[138:139] op_sel_hi:[1,0] neg_lo:[0,1] neg_hi:[0,1]
    v_pk_add_f32 v[124:125], v[124:125], v[138:139] op_sel_hi:[1,0] neg_lo:[0,1] neg_hi:[0,1]
    v_pk_add_f32 v[126:127], v[126:127], v[138:139] op_sel_hi:[1,0] neg_lo:[0,1] neg_hi:[0,1]
    v_cvt_pk_bf16_f32 v18, v108, v109
    v_lshlrev_b32 v108, 16, v18
    v_and_b32 v109, 0xffff0000, v18
    v_cvt_pk_bf16_f32 v19, v110, v111
    v_lshlrev_b32 v110, 16, v19
    v_and_b32 v111, 0xffff0000, v19
    v_cvt_pk_bf16_f32 v20, v112, v113
    v_lshlrev_b32 v112, 16, v20
    v_and_b32 v113, 0xffff0000, v20
    v_cvt_pk_bf16_f32 v21, v114, v115
    v_lshlrev_b32 v114, 16, v21
    v_and_b32 v115, 0xffff0000, v21
    v_cvt_pk_bf16_f32 v22, v116, v117
    v_lshlrev_b32 v116, 16, v22
    v_and_b32 v117, 0xffff0000, v22
    v_cvt_pk_bf16_f32 v23, v118, v119
    v_lshlrev_b32 v118, 16, v23
    v_and_b32 v119, 0xffff0000, v23
    v_cvt_pk_bf16_f32 v24, v120, v121
    v_lshlrev_b32 v120, 16, v24
    v_and_b32 v121, 0xffff0000, v24
    v_cvt_pk_bf16_f32 v25, v122, v123
    v_lshlrev_b32 v122, 16, v25
    v_and_b32 v123, 0xffff0000, v25
    v_cvt_pk_bf16_f32 v26, v124, v125
    v_lshlrev_b32 v124, 16, v26
    v_and_b32 v125, 0xffff0000, v26
    v_cvt_pk_bf16_f32 v27, v126, v127
    v_lshlrev_b32 v126, 16, v27
    v_and_b32 v127, 0xffff0000, v27
    v_pk_mul_f32 v[108:109], v[108:109], v[140:141] op_sel_hi:[1,0]
    v_pk_mul_f32 v[110:111], v[110:111], v[140:141] op_sel_hi:[1,0]
    v_pk_mul_f32 v[112:113], v[112:113], v[140:141] op_sel_hi:[1,0]
    v_pk_mul_f32 v[114:115], v[114:115], v[140:141] op_sel_hi:[1,0]
    v_pk_mul_f32 v[116:117], v[116:117], v[140:141] op_sel_hi:[1,0]
    v_pk_mul_f32 v[118:119], v[118:119], v[140:141] op_sel_hi:[1,0]
    v_pk_mul_f32 v[120:121], v[120:121], v[140:141] op_sel_hi:[1,0]
    v_pk_mul_f32 v[122:123], v[122:123], v[140:141] op_sel_hi:[1,0]
    v_pk_mul_f32 v[124:125], v[124:125], v[140:141] op_sel_hi:[1,0]
    v_pk_mul_f32 v[126:127], v[126:127], v[140:141] op_sel_hi:[1,0]
    v_cvt_pk_bf16_f32 v18, v108, v109
    v_cvt_pk_bf16_f32 v19, v110, v111
    v_cvt_pk_bf16_f32 v20, v112, v113
    v_cvt_pk_bf16_f32 v21, v114, v115
    v_cvt_pk_bf16_f32 v22, v116, v117
    v_cvt_pk_bf16_f32 v23, v118, v119
    v_cvt_pk_bf16_f32 v24, v120, v121
    v_cvt_pk_bf16_f32 v25, v122, v123
    v_cvt_pk_bf16_f32 v26, v124, v125
    v_cvt_pk_bf16_f32 v27, v126, v127
    v_and_b32 v136, 1, v0
    v_cmp_eq_u32 vcc, 1, v136
    v_mov_b32 v136, 0x0c0c0100
    v_mov_b32 v137, 0x01000c0c
    v_cndmask_b32 v136, v136, v137, vcc
    v_mov_b32 v137, 0x0c0c0302
    v_mov_b32 v138, 0x03020c0c
    v_cndmask_b32 v137, v137, v138, vcc
    v_bfe_u32 v139, v0, 1, 2
    v_mov_b32 v138, 0x0c0c0c0c
    v_cmp_eq_u32 vcc, 0, v139
    s_nop 1
    v_cndmask_b32 v128, v138, v136, vcc
    v_cndmask_b32 v132, v138, v137, vcc
    v_cmp_eq_u32 vcc, 1, v139
    s_nop 1
    v_cndmask_b32 v129, v138, v136, vcc
    v_cndmask_b32 v133, v138, v137, vcc
    v_cmp_eq_u32 vcc, 2, v139
    s_nop 1
    v_cndmask_b32 v130, v138, v136, vcc
    v_cndmask_b32 v134, v138, v137, vcc
    v_cmp_eq_u32 vcc, 3, v139
    s_nop 1
    v_cndmask_b32 v131, v138, v136, vcc
    v_cndmask_b32 v135, v138, v137, vcc
    s_mov_b32 s80, 0x7060500
    s_mov_b32 s81, 0x7060501
    s_mov_b32 s82, 0x7060502
    s_mov_b32 s83, 0x7060503
    s_mov_b32 s77, 0xffffff00
    s_mov_b32 s84, 0x0c0c0400
    s_mov_b32 s85, 0x04000c0c
    s_mov_b32 s86, 524288
    s_waitcnt lgkmcnt(0)
    s_add_u32 s87, s87, 1
    s_mul_i32 s78, s87, 0x9E3779B1
    s_lshr_b32 s79, s78, 15
    s_xor_b32 s78, s78, s79
    v_mov_b32 v7, s78
    s_lshl_b32 s11, s4, 13
    s_add_u32 s12, s12, s11
    s_lshl_b32 s11, s5, 10
    s_add_u32 s11, s11, s12
    s_add_u32 s13, s12, 4096
    v_perm_b32 v152, v18, v18, v128
    v_perm_b32 v153, v18, v18, v129
    v_perm_b32 v154, v18, v18, v130
    v_perm_b32 v155, v18, v18, v131
    s_waitcnt vmcnt(0)
    v_perm_b32 v156, v18, v18, v132
    v_perm_b32 v157, v18, v18, v133
    v_perm_b32 v158, v18, v18, v134
    v_perm_b32 v159, v18, v18, v135
    v_mfma_f32_16x16x32_bf16 v[160:163], v[152:155], v[28:31], 0
    v_perm_b32 v152, v19, v19, v128
    v_perm_b32 v153, v19, v19, v129
    v_perm_b32 v154, v19, v19, v130
    v_perm_b32 v155, v19, v19, v131
    v_mfma_f32_16x16x32_bf16 v[160:163], v[156:159], v[32:35], v[160:163]
    v_perm_b32 v156, v19, v19, v132
    v_perm_b32 v157, v19, v19, v133
    v_perm_b32 v158, v19, v19, v134
    v_perm_b32 v159, v19, v19, v135
    v_mfma_f32_16x16x32_bf16 v[160:163], v[152:155], v[36:39], v[160:163]
    v_perm_b32 v152, v20, v20, v128
    v_perm_b32 v153, v20, v20, v129
    v_perm_b32 v154, v20, v20, v130
    v_perm_b32 v155, v20, v20, v131
    v_mfma_f32_16x16x32_bf16 v[160:163], v[156:159], v[40:43], v[160:163]
    v_perm_b32 v156, v20, v20, v132
    v_perm_b32 v157, v20, v20, v133
    v_perm_b32 v158, v20, v20, v134
    v_perm_b32 v159, v20, v20, v135
    v_mfma_f32_16x16x32_bf16 v[160:163], v[152:155], v[44:47], v[160:163]
    v_perm_b32 v152, v21, v21, v128
    v_perm_b32 v153, v21, v21, v129
    v_perm_b32 v154, v21, v21, v130
    v_perm_b32 v155, v21, v21, v131
    v_mfma_f32_16x16x32_bf16 v[160:163], v[156:159], v[48:51], v[160:163]
    v_perm_b32 v156, v21, v21, v132
    v_perm_b32 v157, v21, v21, v133
    v_perm_b32 v158, v21, v21, v134
    v_perm_b32 v159, v21, v21, v135
    v_mfma_f32_16x16x32_bf16 v[160:163], v[152:155], v[52:55], v[160:163]
    v_perm_b32 v152, v22, v22, v128
    v_perm_b32 v153, v22, v22, v129
    v_perm_b32 v154, v22, v22, v130
    v_perm_b32 v155, v22, v22, v131
    v_mfma_f32_16x16x32_bf16 v[160:163], v[156:159], v[56:59], v[160:163]
    v_perm_b32 v156, v22, v22, v132
    v_perm_b32 v157, v22, v22, v133
    v_perm_b32 v158, v22, v22, v134
    v_perm_b32 v159, v22, v22, v135
    v_mfma_f32_16x16x32_bf16 v[160:163], v[152:155], v[60:63], v[160:163]
    v_perm_b32 v152, v23, v23, v128
    v_perm_b32 v153, v23, v23, v129
    v_perm_b32 v154, v23, v23, v130
    v_perm_b32 v155, v23, v23, v131
    v_mfma_f32_16x16x32_bf16 v[160:163], v[156:159], v[64:67], v[160:163]
    v_perm_b32 v156, v23, v23, v132
    v_perm_b32 v157, v23, v23, v133
    v_perm_b32 v158, v23, v23, v134
    v_perm_b32 v159, v23, v23, v135
    v_mfma_f32_16x16x32_bf16 v[160:163], v[152:155], v[68:71], v[160:163]
    v_perm_b32 v152, v24, v24, v128
    v_perm_b32 v153, v24, v24, v129
    v_perm_b32 v154, v24, v24, v130
    v_perm_b32 v155, v24, v24, v131
    v_mfma_f32_16x16x32_bf16 v[160:163], v[156:159], v[72:75], v[160:163]
    v_perm_b32 v156, v24, v24, v132
    v_perm_b32 v157, v24, v24, v133
    v_perm_b32 v158, v24, v24, v134
    v_perm_b32 v159, v24, v24, v135
    v_mfma_f32_16x16x32_bf16 v[160:163], v[152:155], v[76:79], v[160:163]
    v_perm_b32 v152, v25, v25, v128
    v_perm_b32 v153, v25, v25, v129
    v_perm_b32 v154, v25, v25, v130
    v_perm_b32 v155, v25, v25, v131
    v_mfma_f32_16x16x32_bf16 v[160:163], v[156:159], v[80:83], v[160:163]
    v_perm_b32 v156, v25, v25, v132
    v_perm_b32 v157, v25, v25, v133
    v_perm_b32 v158, v25, v25, v134
    v_perm_b32 v159, v25, v25, v135
    v_mfma_f32_16x16x32_bf16 v[160:163], v[152:155], v[84:87], v[160:163]
    v_perm_b32 v152, v26, v26, v128
    v_perm_b32 v153, v26, v26, v129
    v_perm_b32 v154, v26, v26, v130
    v_perm_b32 v155, v26, v26, v131
    v_mfma_f32_16x16x32_bf16 v[160:163], v[156:159], v[88:91], v[160:163]
    v_perm_b32 v156, v26, v26, v132
    v_perm_b32 v157, v26, v26, v133
    v_perm_b32 v158, v26, v26, v134
    v_perm_b32 v159, v26, v26, v135
    v_mfma_f32_16x16x32_bf16 v[160:163], v[152:155], v[92:95], v[160:163]
    v_perm_b32 v152, v27, v27, v128
    v_perm_b32 v153, v27, v27, v129
    v_perm_b32 v154, v27, v27, v130
    v_perm_b32 v155, v27, v27, v131
    v_mfma_f32_16x16x32_bf16 v[160:163], v[156:159], v[96:99], v[160:163]
    v_perm_b32 v156, v27, v27, v132
    v_perm_b32 v157, v27, v27, v133
    v_perm_b32 v158, v27, v27, v134
    v_perm_b32 v159, v27, v27, v135
    v_mfma_f32_16x16x32_bf16 v[160:163], v[152:155], v[100:103], v[160:163]
    s_nop 0
    v_mfma_f32_16x16x32_bf16 v[160:163], v[156:159], v[104:107], v[160:163]
    s_nop 7
    v_perm_b32 v160, v160, v7, s80
    v_perm_b32 v161, v161, v7, s81
    v_perm_b32 v162, v162, v7, s82
    v_perm_b32 v163, v163, v7, s83
    buffer_store_dwordx4 v[160:163], v147, s[56:59], s11 offen sc1
    s_cmp_eq_u32 s3, 4
    s_cbranch_scc1 L_pl
    s_barrier
    s_cmp_ge_u32 s5, 5
    s_cbranch_scc1 L_fin
    s_branch L_pq
L_pl:
    v_and_b32 v1, 7, v0
    v_lshlrev_b32 v1, 10, v1
L_pl2:
    buffer_load_dwordx4 v[164:167], v1, s[56:59], s12 offen offset:1008 sc1
    s_waitcnt vmcnt(0)
    v_perm_b32 v2, v165, v164, s84
    v_perm_b32 v3, v167, v166, s85
    v_or_b32 v2, v2, v3
    v_cmpx_eq_u32 vcc, v2, v7
    s_cmp_eq_u64 exec, -1
    s_mov_b64 exec, -1
    s_cbranch_scc1 L_pl2_ok
    s_sub_u32 s86, s86, 1
    s_cbranch_scc1 L_pl2_ok
    s_branch L_pl2
L_pl2_ok:
L_pq:
    buffer_load_dwordx4 v[164:167], v147, s[56:59], s12 offen offset:0 sc1
    buffer_load_dwordx4 v[168:171], v147, s[56:59], s12 offen offset:1024 sc1
    buffer_load_dwordx4 v[172:175], v147, s[56:59], s12 offen offset:2048 sc1
    buffer_load_dwordx4 v[176:179], v147, s[56:59], s12 offen offset:3072 sc1
    buffer_load_dwordx4 v[180:183], v147, s[56:59], s13 offen offset:0 sc1
    buffer_load_dwordx4 v[184:187], v147, s[56:59], s13 offen offset:1024 sc1
    buffer_load_dwordx4 v[188:191], v147, s[56:59], s13 offen offset:2048 sc1
    buffer_load_dwordx4 v[192:195], v147, s[56:59], s13 offen offset:3072 sc1
    s_waitcnt vmcnt(0)
    v_perm_b32 v2, v165, v164, s84
    v_perm_b32 v3, v167, v166, s85
    v_or_b32 v2, v2, v3
    v_cmpx_eq_u32 vcc, v2, v7
    v_perm_b32 v2, v169, v168, s84
    v_perm_b32 v3, v171, v170, s85
    v_or_b32 v2, v2, v3
    v_cmpx_eq_u32 vcc, v2, v7
    v_perm_b32 v2, v173, v172, s84
    v_perm_b32 v3, v175, v174, s85
    v_or_b32 v2, v2, v3
    v_cmpx_eq_u32 vcc, v2, v7
    v_perm_b32 v2, v177, v176, s84
    v_perm_b32 v3, v179, v178, s85
    v_or_b32 v2, v2, v3
    v_cmpx_eq_u32 vcc, v2, v7
    v_perm_b32 v2, v181, v180, s84
    v_perm_b32 v3, v183, v182, s85
    v_or_b32 v2, v2, v3
    v_cmpx_eq_u32 vcc, v2, v7
    v_perm_b32 v2, v185, v184, s84
    v_perm_b32 v3, v187, v186, s85
    v_or_b32 v2, v2, v3
    v_cmpx_eq_u32 vcc, v2, v7
    v_perm_b32 v2, v189, v188, s84
    v_perm_b32 v3, v191, v190, s85
    v_or_b32 v2, v2, v3
    v_cmpx_eq_u32 vcc, v2, v7
    v_perm_b32 v2, v193, v192, s84
    v_perm_b32 v3, v195, v194, s85
    v_or_b32 v2, v2, v3
    v_cmpx_eq_u32 vcc, v2, v7
    s_cmp_eq_u64 exec, -1
    s_mov_b64 exec, -1
    s_cbranch_scc1 L_pq_ok
    s_sub_u32 s86, s86, 1
    s_cbranch_scc1 L_pq_ok
    s_branch L_pq
L_pq_ok:
    v_and_b32 v164, s77, v164
    v_and_b32 v165, s77, v165
    v_and_b32 v166, s77, v166
    v_and_b32 v167, s77, v167
    v_and_b32 v168, s77, v168
    v_and_b32 v169, s77, v169
    v_and_b32 v170, s77, v170
    v_and_b32 v171, s77, v171
    v_and_b32 v172, s77, v172
    v_and_b32 v173, s77, v173
    v_and_b32 v174, s77, v174
    v_and_b32 v175, s77, v175
    v_and_b32 v176, s77, v176
    v_and_b32 v177, s77, v177
    v_and_b32 v178, s77, v178
    v_and_b32 v179, s77, v179
    v_and_b32 v180, s77, v180
    v_and_b32 v181, s77, v181
    v_and_b32 v182, s77, v182
    v_and_b32 v183, s77, v183
    v_and_b32 v184, s77, v184
    v_and_b32 v185, s77, v185
    v_and_b32 v186, s77, v186
    v_and_b32 v187, s77, v187
    v_and_b32 v188, s77, v188
    v_and_b32 v189, s77, v189
    v_and_b32 v190, s77, v190
    v_and_b32 v191, s77, v191
    v_and_b32 v192, s77, v192
    v_and_b32 v193, s77, v193
    v_and_b32 v194, s77, v194
    v_and_b32 v195, s77, v195
    v_pk_add_f32 v[164:165], v[164:165], v[180:181]
    v_pk_add_f32 v[166:167], v[166:167], v[182:183]
    v_pk_add_f32 v[168:169], v[168:169], v[184:185]
    v_pk_add_f32 v[170:171], v[170:171], v[186:187]
    v_pk_add_f32 v[172:173], v[172:173], v[188:189]
    v_pk_add_f32 v[174:175], v[174:175], v[190:191]
    v_pk_add_f32 v[176:177], v[176:177], v[192:193]
    v_pk_add_f32 v[178:179], v[178:179], v[194:195]
    v_pk_add_f32 v[164:165], v[164:165], v[172:173]
    v_pk_add_f32 v[166:167], v[166:167], v[174:175]
    v_pk_add_f32 v[168:169], v[168:169], v[176:177]
    v_pk_add_f32 v[170:171], v[170:171], v[178:179]
    v_pk_add_f32 v[164:165], v[164:165], v[168:169]
    v_pk_add_f32 v[166:167], v[166:167], v[170:171]
    s_cmp_eq_u32 s3, 5
    s_cbranch_scc1 L_w5
    v_lshrrev_b32 v1, 5, v0
    v_lshlrev_b32 v1, 8, v1
    v_lshl_add_u32 v1, v4, 4, v1
    v_and_b32 v2, 1, v5
    v_lshl_add_u32 v1, v2, 3, v1
    v_cvt_pk_bf16_f32 v2, v164, v165
    v_cvt_pk_bf16_f32 v3, v166, v167
    ds_write_b64 v1, v[2:3] offset:0
    v_mov_b32 v8, -1
    v_mov_b32 v9, -1
    v_mov_b32 v10, -1
    v_mov_b32 v11, -1
    v_mov_b32 v12, 0
    ds_write_b128 v147, v[8:11] offset:5696
    ds_write_b128 v147, v[8:11] offset:6720
    ds_write_b32 v12, v12 offset:5632
    s_waitcnt lgkmcnt(0)
    s_barrier
    s_mul_i32 s11, s4, 512
    s_add_u32 s11, s11, 4194304
    s_add_u32 s48, s38, s11
    s_addc_u32 s49, s39, 0
    s_mov_b32 s50, 0
    s_mov_b32 s51, 4
    v_lshlrev_b32 v13, 2, v0
L4_wait:
    s_sleep 4
    ds_read_b32 v14, v12 offset:5632
    s_waitcnt lgkmcnt(0)
    v_readfirstlane_b32 s52, v14
    s_cmp_eq_u32 s52, 0
    s_cbranch_scc1 L4_wait
L4_grab:
    s_sub_u32 s57, s52, s50
    s_max_u32 s51, s51, s57
    s_min_u32 s51, s51, 48
    s_mov_b32 s53, s51
    s_atomic_add s53, s[48:49], 0 glc
    s_lshl_b32 s58, s50, 2
    v_add_u32 v15, s58, v13
    s_add_u32 s50, s50, s51
    s_bfm_b64 s[54:55], s51, 0
    s_waitcnt lgkmcnt(0)
    s_min_u32 s53, s53, 384
    v_add_u32 v16, s53, v0
    s_add_u32 s56, s53, s51
    s_cmp_ge_u32 s56, 384
    s_cselect_b64 exec, -1, s[54:55]
    ds_write_b32 v15, v16 offset:5696
    s_cbranch_scc1 L4_end
    s_mov_b64 exec, -1
    s_sub_u32 s53, 384, s56
    s_mul_i32 s51, s51, 3
    s_sub_i32 s51, s53, s51
    s_ashr_i32 s51, s51, 4
    s_cmp_gt_u32 s53, 128
    s_cselect_b32 s57, 4, 0
    s_max_i32 s51, s51, s57
    s_cmp_gt_u32 s53, 128
    s_cselect_b32 s59, 0, -5
L4_poll:
    ds_read_b32 v14, v12 offset:5632
    s_waitcnt lgkmcnt(0)
    v_readfirstlane_b32 s52, v14
    s_add_u32 s52, s52, s59
    s_cmp_gt_i32 s52, s50
    s_cbranch_scc1 L4_grab
    s_sleep 1
    s_branch L4_poll
L4_end:
    s_waitcnt lgkmcnt(0)
    s_endpgm
L_w5:
    v_cvt_pk_bf16_f32 v8, v164, v165
    v_lshlrev_b32 v164, 16, v8
    v_and_b32 v165, 0xffff0000, v8
    v_cvt_pk_bf16_f32 v8, v166, v167
    v_lshlrev_b32 v166, 16, v8
    v_and_b32 v167, 0xffff0000, v8
    v_mov_b32 v9, 0xc0135761
    v_mul_f32 v12, v164, v164
    v_fmamk_f32 v12, v12, 0xbdd2d3e8, v9
    v_mul_f32 v12, v12, v164
    v_exp_f32 v12, v12
    s_nop 0
    v_add_f32 v12, 1.0, v12
    v_rcp_f32 v12, v12
    s_nop 0
    v_mul_f32 v12, v164, v12
    v_mul_f32 v13, v165, v165
    v_fmamk_f32 v13, v13, 0xbdd2d3e8, v9
    v_mul_f32 v13, v13, v165
    v_exp_f32 v13, v13
    s_nop 0
    v_add_f32 v13, 1.0, v13
    v_rcp_f32 v13, v13
    s_nop 0
    v_mul_f32 v13, v165, v13
    v_mul_f32 v14, v166, v166
    v_fmamk_f32 v14, v14, 0xbdd2d3e8, v9
    v_mul_f32 v14, v14, v166
    v_exp_f32 v14, v14
    s_nop 0
    v_add_f32 v14, 1.0, v14
    v_rcp_f32 v14, v14
    s_nop 0
    v_mul_f32 v14, v166, v14
    v_mul_f32 v15, v167, v167
    v_fmamk_f32 v15, v15, 0xbdd2d3e8, v9
    v_mul_f32 v15, v15, v167
    v_exp_f32 v15, v15
    s_nop 0
    v_add_f32 v15, 1.0, v15
    v_rcp_f32 v15, v15
    s_nop 0
    v_mul_f32 v15, v167, v15
    v_cvt_pk_bf16_f32 v8, v12, v13
    v_lshlrev_b32 v12, 16, v8
    v_and_b32 v13, 0xffff0000, v8
    v_cvt_pk_bf16_f32 v8, v14, v15
    v_lshlrev_b32 v14, 16, v8
    v_and_b32 v15, 0xffff0000, v8
    v_mul_f32_dpp v12, v164, v12 row_ror:8 row_mask:0xf bank_mask:0xf
    v_mul_f32_dpp v13, v165, v13 row_ror:8 row_mask:0xf bank_mask:0xf
    v_mul_f32_dpp v14, v166, v14 row_ror:8 row_mask:0xf bank_mask:0xf
    v_mul_f32_dpp v15, v167, v15 row_ror:8 row_mask:0xf bank_mask:0xf
    v_cvt_pk_bf16_f32 v2, v12, v13
    v_cvt_pk_bf16_f32 v3, v14, v15
    v_lshrrev_b32 v1, 5, v0
    v_lshlrev_b32 v1, 7, v1
    v_lshl_add_u32 v1, v4, 4, v1
    v_and_b32 v6, 1, v5
    v_lshl_add_u32 v1, v6, 3, v1
    s_mov_b32 exec_lo, 0x00ff00ff
    s_mov_b32 exec_hi, 0x00ff00ff
    ds_write_b64 v1, v[2:3] offset:512
    s_mov_b64 exec, -1
    s_waitcnt lgkmcnt(0)
    v_lshrrev_b32 v2, 2, v4
    v_lshl_add_u32 v2, v5, 3, v2
    v_lshlrev_b32 v2, 8, v2
    v_and_b32 v3, 3, v4
    v_lshl_add_u32 v2, v3, 3, v2
    ds_read_b64_tr_b16 v[28:29], v2 offset:13824
    ds_read_b64_tr_b16 v[30:31], v2 offset:14848
    ds_read_b64_tr_b16 v[32:33], v2 offset:13856
    ds_read_b64_tr_b16 v[34:35], v2 offset:14880
    ds_read_b64_tr_b16 v[36:37], v2 offset:13888
    ds_read_b64_tr_b16 v[38:39], v2 offset:14912
    ds_read_b64_tr_b16 v[40:41], v2 offset:13920
    ds_read_b64_tr_b16 v[42:43], v2 offset:14944
    ds_read_b64_tr_b16 v[44:45], v2 offset:13952
    ds_read_b64_tr_b16 v[46:47], v2 offset:14976
    ds_read_b64_tr_b16 v[48:49], v2 offset:13984
    ds_read_b64_tr_b16 v[50:51], v2 offset:15008
    ds_read_b64_tr_b16 v[52:53], v2 offset:14016
    ds_read_b64_tr_b16 v[54:55], v2 offset:15040
    ds_read_b64_tr_b16 v[56:57], v2 offset:14048
    ds_read_b64_tr_b16 v[58:59], v2 offset:15072
    s_waitcnt lgkmcnt(0)
    ds_read_b64_tr_b16 v[60:61], v2 offset:22016
    ds_read_b64_tr_b16 v[62:63], v2 offset:23040
    ds_read_b64_tr_b16 v[64:65], v2 offset:22048
    ds_read_b64_tr_b16 v[66:67], v2 offset:23072
    ds_read_b64_tr_b16 v[68:69], v2 offset:22080
    ds_read_b64_tr_b16 v[70:71], v2 offset:23104
    ds_read_b64_tr_b16 v[72:73], v2 offset:22112
    ds_read_b64_tr_b16 v[74:75], v2 offset:23136
    ds_read_b64_tr_b16 v[76:77], v2 offset:22144
    ds_read_b64_tr_b16 v[78:79], v2 offset:23168
    ds_read_b64_tr_b16 v[80:81], v2 offset:22176
    ds_read_b64_tr_b16 v[82:83], v2 offset:23200
    ds_read_b64_tr_b16 v[84:85], v2 offset:22208
    ds_read_b64_tr_b16 v[86:87], v2 offset:23232
    ds_read_b64_tr_b16 v[88:89], v2 offset:22240
    ds_read_b64_tr_b16 v[90:91], v2 offset:23264
    s_waitcnt lgkmcnt(0)
    v_and_b32 v1, 1, v0
    v_lshlrev_b32 v2, 7, v1
    v_lshl_add_u32 v2, v5, 4, v2
    ds_read_b128 v[12:15], v2 offset:512
    ds_read_b128 v[16:19], v2 offset:576
    v_lshrrev_b32 v107, 3, v0
    v_lshlrev_b32 v107, 12, v107
    v_and_b32 v2, 7, v0
    v_lshl_add_u32 v107, v2, 4, v107
    s_lshl_b32 s13, s5, 15
    s_lshl_b32 s14, s4, 7
    s_add_u32 s13, s13, s14
    s_add_u32 s13, s13, 786432
    s_mov_b32 s66, 0xffff0000
    s_mov_b32 s67, 0
    s_mov_b32 s68, 0
    s_mov_b32 s69, 0xffff
    s_mov_b32 s70, 0
    s_mov_b32 s71, 0xffff0000
    s_waitcnt lgkmcnt(1)
    v_mfma_f32_16x16x32_bf16 v[112:115], v[12:15], v[28:31], 0
    s_waitcnt lgkmcnt(0)
    v_mfma_f32_16x16x32_bf16 v[112:115], v[16:19], v[60:63], v[112:115]
    v_mfma_f32_16x16x32_bf16 v[116:119], v[12:15], v[32:35], 0
    v_mfma_f32_16x16x32_bf16 v[116:119], v[16:19], v[64:67], v[116:119]
    v_mfma_f32_16x16x32_bf16 v[120:123], v[12:15], v[36:39], 0
    v_mfma_f32_16x16x32_bf16 v[120:123], v[16:19], v[68:71], v[120:123]
    v_mfma_f32_16x16x32_bf16 v[124:127], v[12:15], v[40:43], 0
    v_mfma_f32_16x16x32_bf16 v[124:127], v[16:19], v[72:75], v[124:127]
    v_mfma_f32_16x16x32_bf16 v[128:131], v[12:15], v[44:47], 0
    v_mfma_f32_16x16x32_bf16 v[128:131], v[16:19], v[76:79], v[128:131]
    v_mfma_f32_16x16x32_bf16 v[132:135], v[12:15], v[48:51], 0
    v_mfma_f32_16x16x32_bf16 v[132:135], v[16:19], v[80:83], v[132:135]
    s_nop 1
    v_cndmask_b32 v8, v112, v120, s[66:67]
    v_cndmask_b32 v9, v113, v121, s[66:67]
    v_cndmask_b32 v10, v116, v124, s[66:67]
    v_cndmask_b32 v11, v117, v125, s[66:67]
    v_mfma_f32_16x16x32_bf16 v[136:139], v[12:15], v[52:55], 0
    v_mfma_f32_16x16x32_bf16 v[136:139], v[16:19], v[84:87], v[136:139]
    v_mfma_f32_16x16x32_bf16 v[140:143], v[12:15], v[56:59], 0
    v_mfma_f32_16x16x32_bf16 v[140:143], v[16:19], v[88:91], v[140:143]
    v_cndmask_b32 v8, v8, v128, s[68:69]
    v_cndmask_b32 v9, v9, v129, s[68:69]
    v_cndmask_b32 v10, v10, v132, s[68:69]
    v_cndmask_b32 v11, v11, v133, s[68:69]
    s_nop 1
    v_cndmask_b32 v8, v8, v136, s[70:71]
    v_cndmask_b32 v9, v9, v137, s[70:71]
    v_cndmask_b32 v10, v10, v140, s[70:71]
    v_cndmask_b32 v11, v11, v141, s[70:71]
    v_perm_b32 v8, v8, v7, s80
    v_perm_b32 v9, v9, v7, s81
    v_perm_b32 v10, v10, v7, s82
    v_perm_b32 v11, v11, v7, s83
    buffer_store_dwordx4 v[8:11], v107, s[56:59], s13 offen sc1
L_fin:
    s_waitcnt vmcnt(0)
    s_endpgm
L_w67:
    s_cmp_lt_u32 s4, 24
    s_cselect_b32 s6, 7, 0
    s_cmp_ge_u32 s5, 5
    s_cselect_b32 s6, 7, s6
    s_cmp_eq_u32 s3, s6
    s_cbranch_scc1 L_end
    s_waitcnt lgkmcnt(0)
    s_load_dword s87, s[38:39], 0
    s_mov_b32 s56, s38
    s_mov_b32 s57, s39
    s_mov_b32 s58, 8388608
    s_mov_b32 s59, 0x20000
    v_mov_b32 v108, v147
    s_cmp_ge_u32 s5, 5
    s_cbranch_scc1 L6_nold
    s_cmp_eq_u32 s3, 7
    s_cbranch_scc1 L6_nold
    s_mul_i32 s11, s4, 163840
    s_lshl_b32 s12, s5, 8
    s_add_u32 s11, s11, s12
    s_mov_b32 s60, s24
    s_mov_b32 s61, s25
    s_mov_b32 s62, 5242880
    s_mov_b32 s63, 0x20000
    v_mul_u32_u24 v1, 1280, v5
    v_lshl_add_u32 v1, v4, 4, v1
    s_cmp_ge_u32 s4, 27
    s_cbranch_scc1 L6_nold
    s_mov_b32 s60, s32
    s_mov_b32 s61, s33
    s_mov_b32 s62, 2211840
    s_mov_b32 s63, 0x20000
    s_mul_i32 s11, s4, 81920
    s_add_u32 s11, s11, s12
    s_mov_b32 m0, 13824
    s_nop 0
    buffer_load_dwordx4 v1, s[60:63], s11 offen nt lds
    s_add_u32 m0, m0, 1024
    s_add_u32 s11, s11, 5120
    buffer_load_dwordx4 v1, s[60:63], s11 offen nt lds
    s_add_u32 m0, m0, 1024
    s_add_u32 s11, s11, 5120
    buffer_load_dwordx4 v1, s[60:63], s11 offen nt lds
    s_add_u32 m0, m0, 1024
    s_add_u32 s11, s11, 5120
    buffer_load_dwordx4 v1, s[60:63], s11 offen nt lds
    s_add_u32 m0, m0, 1024
    s_add_u32 s11, s11, 5120
    buffer_load_dwordx4 v1, s[60:63], s11 offen nt lds
    s_add_u32 m0, m0, 1024
    s_add_u32 s11, s11, 5120
    buffer_load_dwordx4 v1, s[60:63], s11 offen nt lds
    s_add_u32 m0, m0, 1024
    s_add_u32 s11, s11, 5120
    buffer_load_dwordx4 v1, s[60:63], s11 offen nt lds
    s_add_u32 m0, m0, 1024
    s_add_u32 s11, s11, 5120
    buffer_load_dwordx4 v1, s[60:63], s11 offen nt lds
    s_add_u32 m0, m0, 1024
    s_add_u32 s11, s11, 5120
    buffer_load_dwordx4 v1, s[60:63], s11 offen nt lds
    s_add_u32 m0, m0, 1024
    s_add_u32 s11, s11, 5120
    buffer_load_dwordx4 v1, s[60:63], s11 offen nt lds
    s_add_u32 m0, m0, 1024
    s_add_u32 s11, s11, 5120
    buffer_load_dwordx4 v1, s[60:63], s11 offen nt lds
    s_add_u32 m0, m0, 1024
    s_add_u32 s11, s11, 5120
    buffer_load_dwordx4 v1, s[60:63], s11 offen nt lds
    s_add_u32 m0, m0, 1024
    s_add_u32 s11, s11, 5120
    buffer_load_dwordx4 v1, s[60:63], s11 offen nt lds
    s_add_u32 m0, m0, 1024
    s_add_u32 s11, s11, 5120
    buffer_load_dwordx4 v1, s[60:63], s11 offen nt lds
    s_add_u32 m0, m0, 1024
    s_add_u32 s11, s11, 5120
    buffer_load_dwordx4 v1, s[60:63], s11 offen nt lds
    s_add_u32 m0, m0, 1024
    s_add_u32 s11, s11, 5120
    buffer_load_dwordx4 v1, s[60:63], s11 offen nt lds
L6_nold:
    s_barrier
    s_mov_b32 s80, 0x7060500
    s_mov_b32 s81, 0x7060501
    s_mov_b32 s82, 0x7060502
    s_mov_b32 s83, 0x7060503
    s_mov_b32 s77, 0xffffff00
    s_mov_b32 s84, 0x0c0c0400
    s_mov_b32 s85, 0x04000c0c
    s_mov_b32 s86, 524288
    s_waitcnt lgkmcnt(0)
    s_add_u32 s87, s87, 1
    s_mul_i32 s78, s87, 0x9E3779B1
    s_lshr_b32 s79, s78, 15
    s_xor_b32 s78, s78, s79
    v_mov_b32 v7, s78
    s_waitcnt vmcnt(0)
    s_barrier
    s_cmp_eq_u32 s3, 7
    s_cbranch_scc1 L_w7
    v_lshrrev_b32 v109, 2, v4
    v_lshl_add_u32 v109, v5, 3, v109
    v_lshlrev_b32 v109, 8, v109
    v_and_b32 v3, 3, v4
    v_lshl_add_u32 v109, v3, 3, v109
    v_add_u32 v109, 30208, v109
    v_add_u32 v110, 65536, v109
    v_lshrrev_b32 v3, 5, v0
    v_mul_u32_u24 v101, 2176, v3
    v_and_b32 v1, 0x1f0, v108
    v_add_u32 v100, v101, v1
    v_subrev_u32 v102, 28, v0
    v_cmp_gt_u32 s[72:73], 8, v102
    v_lshlrev_b32 v102, 4, v102
    v_mov_b32 v2, 1073741824
    v_cndmask_b32 v102, v2, v102, s[72:73]
    v_and_b32 v104, 7, v0
    v_mul_u32_u24 v104, 1152, v104
    v_lshl_add_u32 v104, v3, 6, v104
    v_lshrrev_b32 v105, 1, v108
    v_and_b32 v106, 1, v0
    v_lshlrev_b32 v106, 8, v106
    v_lshl_add_u32 v106, v5, 4, v106
    v_lshrrev_b32 v107, 3, v0
    v_lshlrev_b32 v107, 12, v107
    v_and_b32 v2, 7, v0
    v_lshl_add_u32 v107, v2, 4, v107
    s_lshl_b32 s13, s5, 15
    s_lshl_b32 s14, s4, 7
    s_add_u32 s13, s13, s14
    s_add_u32 s13, s13, 1048576
    s_mov_b32 s66, 0xffff0000
    s_mov_b32 s67, 0
    s_mov_b32 s68, 0
    s_mov_b32 s69, 0xffff
    s_mov_b32 s70, 0
    s_mov_b32 s71, 0xffff0000
    s_add_u32 s14, s13, 1048576
    s_mul_i32 s12, s4, 9216
    s_add_u32 s12, s12, 1310720
    s_mul_i32 s11, s5, 1152
    s_add_u32 s11, s11, s12
    s_add_u32 s15, s12, 4608
    s_mov_b32 s58, 0
    s_mov_b32 s86, 0
    s_branch L6_arm
L6_loop:
    ds_read_b128 v[24:27], v101 offset:3328
    ds_read_b128 v[28:31], v101 offset:3344
    ds_read_b128 v[8:11], v100 offset:1280
    ds_read_b128 v[12:15], v100 offset:1792
    ds_read_b128 v[16:19], v100 offset:2304
    ds_read_b128 v[20:23], v100 offset:2816
    s_waitcnt lgkmcnt(5)
    v_max3_f32 v32, v24, v25, v26
    v_max_f32 v32, v32, v27
    v_and_b32 v32, s77, v32
    v_sub_f32 v24, v24, v32
    v_sub_f32 v25, v25, v32
    v_sub_f32 v26, v26, v32
    v_sub_f32 v27, v27, v32
    v_exp_f32 v24, v24
    v_exp_f32 v25, v25
    v_exp_f32 v26, v26
    v_exp_f32 v27, v27
    s_waitcnt lgkmcnt(0)
    v_mul_f32 v8, v24, v8
    v_mul_f32 v9, v24, v9
    v_mul_f32 v10, v24, v10
    v_mul_f32 v11, v24, v11
    v_fmac_f32 v8, v25, v12
    v_fmac_f32 v9, v25, v13
    v_fmac_f32 v10, v25, v14
    v_fmac_f32 v11, v25, v15
    v_fmac_f32 v8, v26, v16
    v_fmac_f32 v9, v26, v17
    v_fmac_f32 v10, v26, v18
    v_fmac_f32 v11, v26, v19
    v_fmac_f32 v8, v27, v20
    v_fmac_f32 v9, v27, v21
    v_fmac_f32 v10, v27, v22
    v_fmac_f32 v11, v27, v23
    v_perm_b32 v8, v8, v7, s80
    v_perm_b32 v9, v9, v7, s81
    v_perm_b32 v10, v10, v7, s82
    v_perm_b32 v11, v11, v7, s83
    buffer_store_dwordx4 v[8:11], v108, s[56:59], s11 offen sc1
    v_mul_f32 v33, v24, v28
    v_fmac_f32 v33, v25, v29
    v_fmac_f32 v33, v26, v30
    v_fmac_f32 v33, v27, v31
    v_perm_b32 v32, v32, v7, s80
    v_perm_b32 v33, v33, v7, s81
    v_perm_b32 v34, v34, v7, s82
    v_perm_b32 v35, v35, v7, s83
    s_mov_b64 exec, s[72:73]
    buffer_store_dwordx4 v[32:35], v102, s[56:59], s11 offen offset:1024 sc1
    s_mov_b64 exec, -1
    s_cmp_ge_u32 s5, 5
    s_cbranch_scc1 L6_next
    buffer_load_dwordx4 v[28:31], v104, s[56:59], s12 offen offset:1024 sc1
    buffer_load_dwordx4 v[36:39], v108, s[56:59], s12 offen offset:0 sc1
    buffer_load_dwordx4 v[40:43], v108, s[56:59], s12 offen offset:1152 sc1
    buffer_load_dwordx4 v[44:47], v108, s[56:59], s12 offen offset:2304 sc1
    buffer_load_dwordx4 v[48:51], v108, s[56:59], s12 offen offset:3456 sc1
    buffer_load_dwordx4 v[52:55], v108, s[56:59], s15 offen offset:0 sc1
    buffer_load_dwordx4 v[56:59], v108, s[56:59], s15 offen offset:1152 sc1
    buffer_load_dwordx4 v[60:63], v108, s[56:59], s15 offen offset:2304 sc1
    buffer_load_dwordx4 v[64:67], v108, s[56:59], s15 offen offset:3456 sc1
    s_barrier
    ds_read_b64_tr_b16 v[112:113], v109 offset:0
    ds_read_b64_tr_b16 v[114:115], v109 offset:1024
    ds_read_b64_tr_b16 v[116:117], v109 offset:32
    ds_read_b64_tr_b16 v[118:119], v109 offset:1056
    ds_read_b64_tr_b16 v[120:121], v109 offset:64
    ds_read_b64_tr_b16 v[122:123], v109 offset:1088
    ds_read_b64_tr_b16 v[124:125], v109 offset:96
    ds_read_b64_tr_b16 v[126:127], v109 offset:1120
    ds_read_b64_tr_b16 v[128:129], v109 offset:128
    ds_read_b64_tr_b16 v[130:131], v109 offset:1152
    ds_read_b64_tr_b16 v[132:133], v109 offset:160
    ds_read_b64_tr_b16 v[134:135], v109 offset:1184
    ds_read_b64_tr_b16 v[136:137], v109 offset:192
    ds_read_b64_tr_b16 v[138:139], v109 offset:1216
    ds_read_b64_tr_b16 v[140:141], v109 offset:224
    ds_read_b64_tr_b16 v[142:143], v109 offset:1248
    ds_read_b64_tr_b16 v[144:145], v109 offset:32768
    ds_read_b64_tr_b16 v[146:147], v109 offset:33792
    ds_read_b64_tr_b16 v[148:149], v109 offset:32800
    ds_read_b64_tr_b16 v[150:151], v109 offset:33824
    ds_read_b64_tr_b16 v[152:153], v109 offset:32832
    ds_read_b64_tr_b16 v[154:155], v109 offset:33856
    ds_read_b64_tr_b16 v[156:157], v109 offset:32864
    ds_read_b64_tr_b16 v[158:159], v109 offset:33888
    ds_read_b64_tr_b16 v[160:161], v109 offset:32896
    ds_read_b64_tr_b16 v[162:163], v109 offset:33920
    ds_read_b64_tr_b16 v[164:165], v109 offset:32928
    ds_read_b64_tr_b16 v[166:167], v109 offset:33952
    ds_read_b64_tr_b16 v[168:169], v109 offset:32960
    ds_read_b64_tr_b16 v[170:171], v109 offset:33984
    ds_read_b64_tr_b16 v[172:173], v109 offset:32992
    ds_read_b64_tr_b16 v[174:175], v109 offset:34016
    ds_read_b64_tr_b16 v[176:177], v110 offset:0
    ds_read_b64_tr_b16 v[178:179], v110 offset:1024
    ds_read_b64_tr_b16 v[180:181], v110 offset:32
    ds_read_b64_tr_b16 v[182:183], v110 offset:1056
    ds_read_b64_tr_b16 v[184:185], v110 offset:64
    ds_read_b64_tr_b16 v[186:187], v110 offset:1088
    ds_read_b64_tr_b16 v[188:189], v110 offset:96
    ds_read_b64_tr_b16 v[190:191], v110 offset:1120
    ds_read_b64_tr_b16 v[192:193], v110 offset:128
    ds_read_b64_tr_b16 v[194:195], v110 offset:1152
    ds_read_b64_tr_b16 v[196:197], v110 offset:160
    ds_read_b64_tr_b16 v[198:199], v110 offset:1184
    ds_read_b64_tr_b16 v[200:201], v110 offset:192
    ds_read_b64_tr_b16 v[202:203], v110 offset:1216
    ds_read_b64_tr_b16 v[204:205], v110 offset:224
    ds_read_b64_tr_b16 v[206:207], v110 offset:1248
    ds_read_b64_tr_b16 v[208:209], v110 offset:32768
    ds_read_b64_tr_b16 v[210:211], v110 offset:33792
    ds_read_b64_tr_b16 v[212:213], v110 offset:32800
    ds_read_b64_tr_b16 v[214:215], v110 offset:33824
    ds_read_b64_tr_b16 v[216:217], v110 offset:32832
    ds_read_b64_tr_b16 v[218:219], v110 offset:33856
    ds_read_b64_tr_b16 v[220:221], v110 offset:32864
    ds_read_b64_tr_b16 v[222:223], v110 offset:33888
    ds_read_b64_tr_b16 v[224:225], v110 offset:32896
    ds_read_b64_tr_b16 v[226:227], v110 offset:33920
    ds_read_b64_tr_b16 v[228:229], v110 offset:32928
    ds_read_b64_tr_b16 v[230:231], v110 offset:33952
    ds_read_b64_tr_b16 v[232:233], v110 offset:32960
    ds_read_b64_tr_b16 v[234:235], v110 offset:33984
    ds_read_b64_tr_b16 v[236:237], v110 offset:32992
    ds_read_b64_tr_b16 v[238:239], v110 offset:34016
L6_poll:
    buffer_load_dwordx4 v[32:35], v104, s[56:59], s12 offen offset:1024 sc1
    buffer_load_dwordx4 v[68:71], v108, s[56:59], s12 offen offset:0 sc1
    buffer_load_dwordx4 v[72:75], v108, s[56:59], s12 offen offset:1152 sc1
    buffer_load_dwordx4 v[76:79], v108, s[56:59], s12 offen offset:2304 sc1
    buffer_load_dwordx4 v[80:83], v108, s[56:59], s12 offen offset:3456 sc1
    buffer_load_dwordx4 v[84:87], v108, s[56:59], s15 offen offset:0 sc1
    buffer_load_dwordx4 v[88:91], v108, s[56:59], s15 offen offset:1152 sc1
    buffer_load_dwordx4 v[92:95], v108, s[56:59], s15 offen offset:2304 sc1
    buffer_load_dwordx4 v[96:99], v108, s[56:59], s15 offen offset:3456 sc1
    s_waitcnt vmcnt(17)
    v_and_b32 v22, s77, v28
    v_and_b32 v23, s77, v29
    s_nop 0
    v_max_f32_dpp v26, v22, v22 quad_perm:[1,0,3,2] row_mask:0xf bank_mask:0xf
    s_nop 1
    v_max_f32_dpp v26, v26, v26 quad_perm:[2,3,0,1] row_mask:0xf bank_mask:0xf
    s_nop 1
    v_max_f32_dpp v26, v26, v26 row_half_mirror row_mask:0xf bank_mask:0xf
    v_sub_f32 v24, v22, v26
    v_exp_f32 v24, v24
    s_nop 0
    v_mul_f32 v25, v24, v23
    s_nop 1
    v_add_f32_dpp v25, v25, v25 quad_perm:[1,0,3,2] row_mask:0xf bank_mask:0xf
    s_nop 1
    v_add_f32_dpp v25, v25, v25 quad_perm:[2,3,0,1] row_mask:0xf bank_mask:0xf
    s_nop 1
    v_add_f32_dpp v25, v25, v25 row_half_mirror row_mask:0xf bank_mask:0xf
    v_rcp_f32 v25, v25
    s_nop 0
    v_mul_f32 v24, v24, v25
    v_perm_b32 v2, v29, v28, s84
    v_perm_b32 v3, v31, v30, s85
    v_or_b32 v2, v2, v3
    v_cmpx_eq_u32 vcc, v2, v7
    s_waitcnt vmcnt(16)
    v_perm_b32 v2, v37, v36, s84
    v_perm_b32 v3, v39, v38, s85
    v_or_b32 v2, v2, v3
    v_cmpx_eq_u32 vcc, v2, v7
    s_waitcnt vmcnt(15)
    v_perm_b32 v2, v41, v40, s84
    v_perm_b32 v3, v43, v42, s85
    v_or_b32 v2, v2, v3
    v_cmpx_eq_u32 vcc, v2, v7
    s_waitcnt vmcnt(14)
    v_perm_b32 v2, v45, v44, s84
    v_perm_b32 v3, v47, v46, s85
    v_or_b32 v2, v2, v3
    v_cmpx_eq_u32 vcc, v2, v7
    s_waitcnt vmcnt(13)
    v_perm_b32 v2, v49, v48, s84
    v_perm_b32 v3, v51, v50, s85
    v_or_b32 v2, v2, v3
    v_cmpx_eq_u32 vcc, v2, v7
    s_waitcnt vmcnt(12)
    v_perm_b32 v2, v53, v52, s84
    v_perm_b32 v3, v55, v54, s85
    v_or_b32 v2, v2, v3
    v_cmpx_eq_u32 vcc, v2, v7
    s_waitcnt vmcnt(11)
    v_perm_b32 v2, v57, v56, s84
    v_perm_b32 v3, v59, v58, s85
    v_or_b32 v2, v2, v3
    v_cmpx_eq_u32 vcc, v2, v7
    s_waitcnt vmcnt(10)
    v_perm_b32 v2, v61, v60, s84
    v_perm_b32 v3, v63, v62, s85
    v_or_b32 v2, v2, v3
    v_cmpx_eq_u32 vcc, v2, v7
    s_waitcnt vmcnt(9)
    v_perm_b32 v2, v65, v64, s84
    v_perm_b32 v3, v67, v66, s85
    v_or_b32 v2, v2, v3
    v_cmpx_eq_u32 vcc, v2, v7
    s_cmp_eq_u64 exec, -1
    s_mov_b64 exec, -1
    s_cbranch_scc1 L6_okA
    buffer_load_dwordx4 v[28:31], v104, s[56:59], s12 offen offset:1024 sc1
    buffer_load_dwordx4 v[36:39], v108, s[56:59], s12 offen offset:0 sc1
    buffer_load_dwordx4 v[40:43], v108, s[56:59], s12 offen offset:1152 sc1
    buffer_load_dwordx4 v[44:47], v108, s[56:59], s12 offen offset:2304 sc1
    buffer_load_dwordx4 v[48:51], v108, s[56:59], s12 offen offset:3456 sc1
    buffer_load_dwordx4 v[52:55], v108, s[56:59], s15 offen offset:0 sc1
    buffer_load_dwordx4 v[56:59], v108, s[56:59], s15 offen offset:1152 sc1
    buffer_load_dwordx4 v[60:63], v108, s[56:59], s15 offen offset:2304 sc1
    buffer_load_dwordx4 v[64:67], v108, s[56:59], s15 offen offset:3456 sc1
    s_waitcnt vmcnt(17)
    v_and_b32 v22, s77, v32
    v_and_b32 v23, s77, v33
    s_nop 0
    v_max_f32_dpp v26, v22, v22 quad_perm:[1,0,3,2] row_mask:0xf bank_mask:0xf
    s_nop 1
    v_max_f32_dpp v26, v26, v26 quad_perm:[2,3,0,1] row_mask:0xf bank_mask:0xf
    s_nop 1
    v_max_f32_dpp v26, v26, v26 row_half_mirror row_mask:0xf bank_mask:0xf
    v_sub_f32 v24, v22, v26
    v_exp_f32 v24, v24
    s_nop 0
    v_mul_f32 v25, v24, v23
    s_nop 1
    v_add_f32_dpp v25, v25, v25 quad_perm:[1,0,3,2] row_mask:0xf bank_mask:0xf
    s_nop 1
    v_add_f32_dpp v25, v25, v25 quad_perm:[2,3,0,1] row_mask:0xf bank_mask:0xf
    s_nop 1
    v_add_f32_dpp v25, v25, v25 row_half_mirror row_mask:0xf bank_mask:0xf
    v_rcp_f32 v25, v25
    s_nop 0
    v_mul_f32 v24, v24, v25
    v_perm_b32 v2, v33, v32, s84
    v_perm_b32 v3, v35, v34, s85
    v_or_b32 v2, v2, v3
    v_cmpx_eq_u32 vcc, v2, v7
    s_waitcnt vmcnt(16)
    v_perm_b32 v2, v69, v68, s84
    v_perm_b32 v3, v71, v70, s85
    v_or_b32 v2, v2, v3
    v_cmpx_eq_u32 vcc, v2, v7
    s_waitcnt vmcnt(15)
    v_perm_b32 v2, v73, v72, s84
    v_perm_b32 v3, v75, v74, s85
    v_or_b32 v2, v2, v3
    v_cmpx_eq_u32 vcc, v2, v7
    s_waitcnt vmcnt(14)
    v_perm_b32 v2, v77, v76, s84
    v_perm_b32 v3, v79, v78, s85
    v_or_b32 v2, v2, v3
    v_cmpx_eq_u32 vcc, v2, v7
    s_waitcnt vmcnt(13)
    v_perm_b32 v2, v81, v80, s84
    v_perm_b32 v3, v83, v82, s85
    v_or_b32 v2, v2, v3
    v_cmpx_eq_u32 vcc, v2, v7
    s_waitcnt vmcnt(12)
    v_perm_b32 v2, v85, v84, s84
    v_perm_b32 v3, v87, v86, s85
    v_or_b32 v2, v2, v3
    v_cmpx_eq_u32 vcc, v2, v7
    s_waitcnt vmcnt(11)
    v_perm_b32 v2, v89, v88, s84
    v_perm_b32 v3, v91, v90, s85
    v_or_b32 v2, v2, v3
    v_cmpx_eq_u32 vcc, v2, v7
    s_waitcnt vmcnt(10)
    v_perm_b32 v2, v93, v92, s84
    v_perm_b32 v3, v95, v94, s85
    v_or_b32 v2, v2, v3
    v_cmpx_eq_u32 vcc, v2, v7
    s_waitcnt vmcnt(9)
    v_perm_b32 v2, v97, v96, s84
    v_perm_b32 v3, v99, v98, s85
    v_or_b32 v2, v2, v3
    v_cmpx_eq_u32 vcc, v2, v7
    s_cmp_eq_u64 exec, -1
    s_mov_b64 exec, -1
    s_cbranch_scc1 L6_okB
    s_sub_u32 s86, s86, 1
    s_cbranch_scc0 L6_poll
L6_okB:
    v_and_b32 v68, s77, v68
    v_and_b32 v69, s77, v69
    v_and_b32 v70, s77, v70
    v_and_b32 v71, s77, v71
    v_and_b32 v72, s77, v72
    v_and_b32 v73, s77, v73
    v_and_b32 v74, s77, v74
    v_and_b32 v75, s77, v75
    v_and_b32 v76, s77, v76
    v_and_b32 v77, s77, v77
    v_and_b32 v78, s77, v78
    v_and_b32 v79, s77, v79
    v_and_b32 v80, s77, v80
    v_and_b32 v81, s77, v81
    v_and_b32 v82, s77, v82
    v_and_b32 v83, s77, v83
    v_and_b32 v84, s77, v84
    v_and_b32 v85, s77, v85
    v_and_b32 v86, s77, v86
    v_and_b32 v87, s77, v87
    v_and_b32 v88, s77, v88
    v_and_b32 v89, s77, v89
    v_and_b32 v90, s77, v90
    v_and_b32 v91, s77, v91
    v_and_b32 v92, s77, v92
    v_and_b32 v93, s77, v93
    v_and_b32 v94, s77, v94
    v_and_b32 v95, s77, v95
    v_and_b32 v96, s77, v96
    v_and_b32 v97, s77, v97
    v_and_b32 v98, s77, v98
    v_and_b32 v99, s77, v99
    v_mul_f32_dpp v8, v24, v68 row_newbcast:0 row_mask:0xf bank_mask:0xf
    v_mul_f32_dpp v9, v24, v69 row_newbcast:0 row_mask:0xf bank_mask:0xf
    v_mul_f32_dpp v10, v24, v70 row_newbcast:0 row_mask:0xf bank_mask:0xf
    v_mul_f32_dpp v11, v24, v71 row_newbcast:0 row_mask:0xf bank_mask:0xf
    v_fmac_f32_dpp v8, v24, v72 row_newbcast:1 row_mask:0xf bank_mask:0xf
    v_fmac_f32_dpp v9, v24, v73 row_newbcast:1 row_mask:0xf bank_mask:0xf
    v_fmac_f32_dpp v10, v24, v74 row_newbcast:1 row_mask:0xf bank_mask:0xf
    v_fmac_f32_dpp v11, v24, v75 row_newbcast:1 row_mask:0xf bank_mask:0xf
    v_fmac_f32_dpp v8, v24, v76 row_newbcast:2 row_mask:0xf bank_mask:0xf
    v_fmac_f32_dpp v9, v24, v77 row_newbcast:2 row_mask:0xf bank_mask:0xf
    v_fmac_f32_dpp v10, v24, v78 row_newbcast:2 row_mask:0xf bank_mask:0xf
    v_fmac_f32_dpp v11, v24, v79 row_newbcast:2 row_mask:0xf bank_mask:0xf
    v_fmac_f32_dpp v8, v24, v80 row_newbcast:3 row_mask:0xf bank_mask:0xf
    v_fmac_f32_dpp v9, v24, v81 row_newbcast:3 row_mask:0xf bank_mask:0xf
    v_fmac_f32_dpp v10, v24, v82 row_newbcast:3 row_mask:0xf bank_mask:0xf
    v_fmac_f32_dpp v11, v24, v83 row_newbcast:3 row_mask:0xf bank_mask:0xf
    v_fmac_f32_dpp v8, v24, v84 row_newbcast:4 row_mask:0xf bank_mask:0xf
    v_fmac_f32_dpp v9, v24, v85 row_newbcast:4 row_mask:0xf bank_mask:0xf
    v_fmac_f32_dpp v10, v24, v86 row_newbcast:4 row_mask:0xf bank_mask:0xf
    v_fmac_f32_dpp v11, v24, v87 row_newbcast:4 row_mask:0xf bank_mask:0xf
    v_fmac_f32_dpp v8, v24, v88 row_newbcast:5 row_mask:0xf bank_mask:0xf
    v_fmac_f32_dpp v9, v24, v89 row_newbcast:5 row_mask:0xf bank_mask:0xf
    v_fmac_f32_dpp v10, v24, v90 row_newbcast:5 row_mask:0xf bank_mask:0xf
    v_fmac_f32_dpp v11, v24, v91 row_newbcast:5 row_mask:0xf bank_mask:0xf
    v_fmac_f32_dpp v8, v24, v92 row_newbcast:6 row_mask:0xf bank_mask:0xf
    v_fmac_f32_dpp v9, v24, v93 row_newbcast:6 row_mask:0xf bank_mask:0xf
    v_fmac_f32_dpp v10, v24, v94 row_newbcast:6 row_mask:0xf bank_mask:0xf
    v_fmac_f32_dpp v11, v24, v95 row_newbcast:6 row_mask:0xf bank_mask:0xf
    v_fmac_f32_dpp v8, v24, v96 row_newbcast:7 row_mask:0xf bank_mask:0xf
    v_fmac_f32_dpp v9, v24, v97 row_newbcast:7 row_mask:0xf bank_mask:0xf
    v_fmac_f32_dpp v10, v24, v98 row_newbcast:7 row_mask:0xf bank_mask:0xf
    v_fmac_f32_dpp v11, v24, v99 row_newbcast:7 row_mask:0xf bank_mask:0xf
    v_cvt_pk_bf16_f32 v8, v8, v9
    v_cvt_pk_bf16_f32 v9, v10, v11
    ds_write_b64 v105, v[8:9] offset:768
    s_waitcnt lgkmcnt(0)
    ds_read_b128 v[8:11], v106 offset:768
    ds_read_b128 v[12:15], v106 offset:832
    ds_read_b128 v[16:19], v106 offset:896
    ds_read_b128 v[20:23], v106 offset:960
    s_waitcnt lgkmcnt(3)
    v_mfma_f32_16x16x32_bf16 v[68:71], v[8:11], v[112:115], 0
    s_waitcnt lgkmcnt(2)
    v_mfma_f32_16x16x32_bf16 v[68:71], v[12:15], v[144:147], v[68:71]
    s_waitcnt lgkmcnt(1)
    v_mfma_f32_16x16x32_bf16 v[68:71], v[16:19], v[176:179], v[68:71]
    s_waitcnt lgkmcnt(0)
    v_mfma_f32_16x16x32_bf16 v[68:71], v[20:23], v[208:211], v[68:71]
    v_mfma_f32_16x16x32_bf16 v[72:75], v[8:11], v[116:119], 0
    v_mfma_f32_16x16x32_bf16 v[72:75], v[12:15], v[148:151], v[72:75]
    v_mfma_f32_16x16x32_bf16 v[72:75], v[16:19], v[180:183], v[72:75]
    v_mfma_f32_16x16x32_bf16 v[72:75], v[20:23], v[212:215], v[72:75]
    v_mfma_f32_16x16x32_bf16 v[76:79], v[8:11], v[120:123], 0
    v_mfma_f32_16x16x32_bf16 v[76:79], v[12:15], v[152:155], v[76:79]
    v_mfma_f32_16x16x32_bf16 v[76:79], v[16:19], v[184:187], v[76:79]
    v_mfma_f32_16x16x32_bf16 v[76:79], v[20:23], v[216:219], v[76:79]
    v_mfma_f32_16x16x32_bf16 v[80:83], v[8:11], v[124:127], 0
    v_mfma_f32_16x16x32_bf16 v[80:83], v[12:15], v[156:159], v[80:83]
    v_mfma_f32_16x16x32_bf16 v[80:83], v[16:19], v[188:191], v[80:83]
    v_mfma_f32_16x16x32_bf16 v[80:83], v[20:23], v[220:223], v[80:83]
    v_mfma_f32_16x16x32_bf16 v[84:87], v[8:11], v[128:131], 0
    v_mfma_f32_16x16x32_bf16 v[84:87], v[12:15], v[160:163], v[84:87]
    v_mfma_f32_16x16x32_bf16 v[84:87], v[16:19], v[192:195], v[84:87]
    v_mfma_f32_16x16x32_bf16 v[84:87], v[20:23], v[224:227], v[84:87]
    v_mfma_f32_16x16x32_bf16 v[88:91], v[8:11], v[132:135], 0
    v_mfma_f32_16x16x32_bf16 v[88:91], v[12:15], v[164:167], v[88:91]
    v_mfma_f32_16x16x32_bf16 v[88:91], v[16:19], v[196:199], v[88:91]
    v_mfma_f32_16x16x32_bf16 v[88:91], v[20:23], v[228:231], v[88:91]
    v_cndmask_b32 v24, v68, v76, s[66:67]
    v_cndmask_b32 v25, v69, v77, s[66:67]
    v_cndmask_b32 v26, v72, v80, s[66:67]
    v_cndmask_b32 v27, v73, v81, s[66:67]
    v_mfma_f32_16x16x32_bf16 v[92:95], v[8:11], v[136:139], 0
    v_mfma_f32_16x16x32_bf16 v[92:95], v[12:15], v[168:171], v[92:95]
    v_mfma_f32_16x16x32_bf16 v[92:95], v[16:19], v[200:203], v[92:95]
    v_mfma_f32_16x16x32_bf16 v[92:95], v[20:23], v[232:235], v[92:95]
    v_mfma_f32_16x16x32_bf16 v[96:99], v[8:11], v[140:143], 0
    v_mfma_f32_16x16x32_bf16 v[96:99], v[12:15], v[172:175], v[96:99]
    v_mfma_f32_16x16x32_bf16 v[96:99], v[16:19], v[204:207], v[96:99]
    v_mfma_f32_16x16x32_bf16 v[96:99], v[20:23], v[236:239], v[96:99]
    v_cndmask_b32 v24, v24, v84, s[68:69]
    v_cndmask_b32 v25, v25, v85, s[68:69]
    v_cndmask_b32 v26, v26, v88, s[68:69]
    v_cndmask_b32 v27, v27, v89, s[68:69]
    v_cndmask_b32 v24, v24, v92, s[70:71]
    v_cndmask_b32 v25, v25, v93, s[70:71]
    s_nop 1
    v_cndmask_b32 v26, v26, v96, s[70:71]
    v_cndmask_b32 v27, v27, v97, s[70:71]
    v_perm_b32 v24, v24, v7, s80
    v_perm_b32 v25, v25, v7, s81
    v_perm_b32 v26, v26, v7, s82
    v_perm_b32 v27, v27, v7, s83
    buffer_store_dwordx4 v[24:27], v107, s[56:59], s14 offen
    buffer_store_dwordx4 v[24:27], v107, s[56:59], s13 offen sc1
    s_branch L6_next
L6_okA:
    v_and_b32 v36, s77, v36
    v_and_b32 v37, s77, v37
    v_and_b32 v38, s77, v38
    v_and_b32 v39, s77, v39
    v_and_b32 v40, s77, v40
    v_and_b32 v41, s77, v41
    v_and_b32 v42, s77, v42
    v_and_b32 v43, s77, v43
    v_and_b32 v44, s77, v44
    v_and_b32 v45, s77, v45
    v_and_b32 v46, s77, v46
    v_and_b32 v47, s77, v47
    v_and_b32 v48, s77, v48
    v_and_b32 v49, s77, v49
    v_and_b32 v50, s77, v50
    v_and_b32 v51, s77, v51
    v_and_b32 v52, s77, v52
    v_and_b32 v53, s77, v53
    v_and_b32 v54, s77, v54
    v_and_b32 v55, s77, v55
    v_and_b32 v56, s77, v56
    v_and_b32 v57, s77, v57
    v_and_b32 v58, s77, v58
    v_and_b32 v59, s77, v59
    v_and_b32 v60, s77, v60
    v_and_b32 v61, s77, v61
    v_and_b32 v62, s77, v62
    v_and_b32 v63, s77, v63
    v_and_b32 v64, s77, v64
    v_and_b32 v65, s77, v65
    v_and_b32 v66, s77, v66
    v_and_b32 v67, s77, v67
    v_mul_f32_dpp v8, v24, v36 row_newbcast:0 row_mask:0xf bank_mask:0xf
    v_mul_f32_dpp v9, v24, v37 row_newbcast:0 row_mask:0xf bank_mask:0xf
    v_mul_f32_dpp v10, v24, v38 row_newbcast:0 row_mask:0xf bank_mask:0xf
    v_mul_f32_dpp v11, v24, v39 row_newbcast:0 row_mask:0xf bank_mask:0xf
    v_fmac_f32_dpp v8, v24, v40 row_newbcast:1 row_mask:0xf bank_mask:0xf
    v_fmac_f32_dpp v9, v24, v41 row_newbcast:1 row_mask:0xf bank_mask:0xf
    v_fmac_f32_dpp v10, v24, v42 row_newbcast:1 row_mask:0xf bank_mask:0xf
    v_fmac_f32_dpp v11, v24, v43 row_newbcast:1 row_mask:0xf bank_mask:0xf
    v_fmac_f32_dpp v8, v24, v44 row_newbcast:2 row_mask:0xf bank_mask:0xf
    v_fmac_f32_dpp v9, v24, v45 row_newbcast:2 row_mask:0xf bank_mask:0xf
    v_fmac_f32_dpp v10, v24, v46 row_newbcast:2 row_mask:0xf bank_mask:0xf
    v_fmac_f32_dpp v11, v24, v47 row_newbcast:2 row_mask:0xf bank_mask:0xf
    v_fmac_f32_dpp v8, v24, v48 row_newbcast:3 row_mask:0xf bank_mask:0xf
    v_fmac_f32_dpp v9, v24, v49 row_newbcast:3 row_mask:0xf bank_mask:0xf
    v_fmac_f32_dpp v10, v24, v50 row_newbcast:3 row_mask:0xf bank_mask:0xf
    v_fmac_f32_dpp v11, v24, v51 row_newbcast:3 row_mask:0xf bank_mask:0xf
    v_fmac_f32_dpp v8, v24, v52 row_newbcast:4 row_mask:0xf bank_mask:0xf
    v_fmac_f32_dpp v9, v24, v53 row_newbcast:4 row_mask:0xf bank_mask:0xf
    v_fmac_f32_dpp v10, v24, v54 row_newbcast:4 row_mask:0xf bank_mask:0xf
    v_fmac_f32_dpp v11, v24, v55 row_newbcast:4 row_mask:0xf bank_mask:0xf
    v_fmac_f32_dpp v8, v24, v56 row_newbcast:5 row_mask:0xf bank_mask:0xf
    v_fmac_f32_dpp v9, v24, v57 row_newbcast:5 row_mask:0xf bank_mask:0xf
    v_fmac_f32_dpp v10, v24, v58 row_newbcast:5 row_mask:0xf bank_mask:0xf
    v_fmac_f32_dpp v11, v24, v59 row_newbcast:5 row_mask:0xf bank_mask:0xf
    v_fmac_f32_dpp v8, v24, v60 row_newbcast:6 row_mask:0xf bank_mask:0xf
    v_fmac_f32_dpp v9, v24, v61 row_newbcast:6 row_mask:0xf bank_mask:0xf
    v_fmac_f32_dpp v10, v24, v62 row_newbcast:6 row_mask:0xf bank_mask:0xf
    v_fmac_f32_dpp v11, v24, v63 row_newbcast:6 row_mask:0xf bank_mask:0xf
    v_fmac_f32_dpp v8, v24, v64 row_newbcast:7 row_mask:0xf bank_mask:0xf
    v_fmac_f32_dpp v9, v24, v65 row_newbcast:7 row_mask:0xf bank_mask:0xf
    v_fmac_f32_dpp v10, v24, v66 row_newbcast:7 row_mask:0xf bank_mask:0xf
    v_fmac_f32_dpp v11, v24, v67 row_newbcast:7 row_mask:0xf bank_mask:0xf
    v_cvt_pk_bf16_f32 v8, v8, v9
    v_cvt_pk_bf16_f32 v9, v10, v11
    ds_write_b64 v105, v[8:9] offset:768
    s_waitcnt lgkmcnt(0)
    ds_read_b128 v[8:11], v106 offset:768
    ds_read_b128 v[12:15], v106 offset:832
    ds_read_b128 v[16:19], v106 offset:896
    ds_read_b128 v[20:23], v106 offset:960
    s_waitcnt lgkmcnt(3)
    v_mfma_f32_16x16x32_bf16 v[36:39], v[8:11], v[112:115], 0
    s_waitcnt lgkmcnt(2)
    v_mfma_f32_16x16x32_bf16 v[36:39], v[12:15], v[144:147], v[36:39]
    s_waitcnt lgkmcnt(1)
    v_mfma_f32_16x16x32_bf16 v[36:39], v[16:19], v[176:179], v[36:39]
    s_waitcnt lgkmcnt(0)
    v_mfma_f32_16x16x32_bf16 v[36:39], v[20:23], v[208:211], v[36:39]
    v_mfma_f32_16x16x32_bf16 v[40:43], v[8:11], v[116:119], 0
    v_mfma_f32_16x16x32_bf16 v[40:43], v[12:15], v[148:151], v[40:43]
    v_mfma_f32_16x16x32_bf16 v[40:43], v[16:19], v[180:183], v[40:43]
    v_mfma_f32_16x16x32_bf16 v[40:43], v[20:23], v[212:215], v[40:43]
    v_mfma_f32_16x16x32_bf16 v[44:47], v[8:11], v[120:123], 0
    v_mfma_f32_16x16x32_bf16 v[44:47], v[12:15], v[152:155], v[44:47]
    v_mfma_f32_16x16x32_bf16 v[44:47], v[16:19], v[184:187], v[44:47]
    v_mfma_f32_16x16x32_bf16 v[44:47], v[20:23], v[216:219], v[44:47]
    v_mfma_f32_16x16x32_bf16 v[48:51], v[8:11], v[124:127], 0
    v_mfma_f32_16x16x32_bf16 v[48:51], v[12:15], v[156:159], v[48:51]
    v_mfma_f32_16x16x32_bf16 v[48:51], v[16:19], v[188:191], v[48:51]
    v_mfma_f32_16x16x32_bf16 v[48:51], v[20:23], v[220:223], v[48:51]
    v_mfma_f32_16x16x32_bf16 v[52:55], v[8:11], v[128:131], 0
    v_mfma_f32_16x16x32_bf16 v[52:55], v[12:15], v[160:163], v[52:55]
    v_mfma_f32_16x16x32_bf16 v[52:55], v[16:19], v[192:195], v[52:55]
    v_mfma_f32_16x16x32_bf16 v[52:55], v[20:23], v[224:227], v[52:55]
    v_mfma_f32_16x16x32_bf16 v[56:59], v[8:11], v[132:135], 0
    v_mfma_f32_16x16x32_bf16 v[56:59], v[12:15], v[164:167], v[56:59]
    v_mfma_f32_16x16x32_bf16 v[56:59], v[16:19], v[196:199], v[56:59]
    v_mfma_f32_16x16x32_bf16 v[56:59], v[20:23], v[228:231], v[56:59]
    v_cndmask_b32 v24, v36, v44, s[66:67]
    v_cndmask_b32 v25, v37, v45, s[66:67]
    v_cndmask_b32 v26, v40, v48, s[66:67]
    v_cndmask_b32 v27, v41, v49, s[66:67]
    v_mfma_f32_16x16x32_bf16 v[60:63], v[8:11], v[136:139], 0
    v_mfma_f32_16x16x32_bf16 v[60:63], v[12:15], v[168:171], v[60:63]
    v_mfma_f32_16x16x32_bf16 v[60:63], v[16:19], v[200:203], v[60:63]
    v_mfma_f32_16x16x32_bf16 v[60:63], v[20:23], v[232:235], v[60:63]
    v_mfma_f32_16x16x32_bf16 v[64:67], v[8:11], v[140:143], 0
    v_mfma_f32_16x16x32_bf16 v[64:67], v[12:15], v[172:175], v[64:67]
    v_mfma_f32_16x16x32_bf16 v[64:67], v[16:19], v[204:207], v[64:67]
    v_mfma_f32_16x16x32_bf16 v[64:67], v[20:23], v[236:239], v[64:67]
    v_cndmask_b32 v24, v24, v52, s[68:69]
    v_cndmask_b32 v25, v25, v53, s[68:69]
    v_cndmask_b32 v26, v26, v56, s[68:69]
    v_cndmask_b32 v27, v27, v57, s[68:69]
    v_cndmask_b32 v24, v24, v60, s[70:71]
    v_cndmask_b32 v25, v25, v61, s[70:71]
    s_nop 1
    v_cndmask_b32 v26, v26, v64, s[70:71]
    v_cndmask_b32 v27, v27, v65, s[70:71]
    v_perm_b32 v24, v24, v7, s80
    v_perm_b32 v25, v25, v7, s81
    v_perm_b32 v26, v26, v7, s82
    v_perm_b32 v27, v27, v7, s83
    buffer_store_dwordx4 v[24:27], v107, s[56:59], s14 offen
    buffer_store_dwordx4 v[24:27], v107, s[56:59], s13 offen sc1
L6_next:
    s_cmp_lg_u32 s58, 0
    s_cbranch_scc1 L6_done
L6_arm:
    s_waitcnt vmcnt(0)
    s_mov_b32 s58, 8388608
    s_mov_b32 s86, 524288
    s_barrier
    s_branch L6_loop
L6_done:
    s_waitcnt vmcnt(0)
    s_endpgm
L_w7:
    s_mul_i32 s8, s5, 8
    s_add_u32 s8, s8, s4
    s_sub_u32 s8, s8, 24
    s_mov_b32 s40, s16
    s_mov_b32 s41, s17
    s_mov_b32 s42, 2560
    s_mov_b32 s43, 0x20000
    s_mov_b32 s68, s34
    s_mov_b32 s69, s35
    s_mov_b32 s70, 2560
    s_mov_b32 s71, 0x20000
    v_and_b32 v1, 7, v0
    v_lshrrev_b32 v2, 1, v5
    v_lshl_add_u32 v1, v2, 4, v1
    v_lshlrev_b32 v1, 1, v1
    v_and_b32 v2, 1, v5
    v_mul_u32_u24 v2, 1280, v2
    v_add_u32 v1, v1, v2
    v_mov_b32 v30, 1073741824
    v_cmp_gt_u32 vcc, 8, v4
    s_nop 1
    v_cndmask_b32 v29, v30, v1, vcc
    v_cmp_gt_u32 s[64:65], 24, v0
    v_add_u32 v32, 3072, v147
    s_nop 0
    v_cndmask_b32 v31, v147, v32, s[64:65]
    s_and_b32 s10, s8, 1
    s_lshl_b32 s10, s10, 4
    s_and_b32 s11, s8, 62
    s_lshl_b32 s11, s11, 5
    s_add_u32 s10, s10, s11
    s_lshl_b32 s13, s8, 12
    s_add_u32 s13, s13, 786432
    s_mov_b32 s9, 0
    s_mov_b32 s15, -1
    buffer_load_short_d16_hi v28, v1, s[40:43], s10 offen
L7_py:
    s_cmp_lg_u32 s9, 0
    s_cbranch_scc1 L7_ns
    s_sleep 127
L7_ns:
    buffer_load_dwordx4 v[8:11], v147, s[56:59], s13 offen offset:0 sc1
    buffer_load_dwordx4 v[12:15], v147, s[56:59], s13 offen offset:1024 sc1
    buffer_load_dwordx4 v[16:19], v147, s[56:59], s13 offen offset:2048 sc1
    buffer_load_dwordx4 v[20:23], v31, s[56:59], s13 offen sc1
    s_waitcnt vmcnt(3)
    v_perm_b32 v2, v9, v8, s84
    v_perm_b32 v3, v11, v10, s85
    v_or_b32 v2, v2, v3
    v_cmpx_eq_u32 vcc, v2, v7
    s_waitcnt vmcnt(2)
    v_perm_b32 v2, v13, v12, s84
    v_perm_b32 v3, v15, v14, s85
    v_or_b32 v2, v2, v3
    v_cmpx_eq_u32 vcc, v2, v7
    s_waitcnt vmcnt(1)
    v_perm_b32 v2, v17, v16, s84
    v_perm_b32 v3, v19, v18, s85
    v_or_b32 v2, v2, v3
    v_cmpx_eq_u32 vcc, v2, v7
    s_waitcnt vmcnt(0)
    v_perm_b32 v2, v21, v20, s84
    v_perm_b32 v3, v23, v22, s85
    v_or_b32 v2, v2, v3
    v_cmpx_eq_u32 vcc, v2, v7
    s_cmp_eq_u64 exec, -1
    s_mov_b64 exec, -1
    s_cbranch_scc1 L7_py_ok
    s_sub_u32 s86, s86, 1
    s_cbranch_scc1 L7_py_ok
    s_cmp_eq_u32 s86, s15
    s_cselect_b32 s14, 1048576, 0
    s_sub_u32 s13, s13, s14
    s_branch L7_py
L7_py_ok:
    v_and_b32 v8, s77, v8
    v_and_b32 v9, s77, v9
    v_and_b32 v10, s77, v10
    v_and_b32 v11, s77, v11
    v_and_b32 v12, s77, v12
    v_and_b32 v13, s77, v13
    v_and_b32 v14, s77, v14
    v_and_b32 v15, s77, v15
    v_and_b32 v16, s77, v16
    v_and_b32 v17, s77, v17
    v_and_b32 v18, s77, v18
    v_and_b32 v19, s77, v19
    v_and_b32 v20, s77, v20
    v_and_b32 v21, s77, v21
    v_and_b32 v22, s77, v22
    v_and_b32 v23, s77, v23
    v_cndmask_b32 v20, 0, v20, s[64:65]
    v_cndmask_b32 v21, 0, v21, s[64:65]
    v_cndmask_b32 v22, 0, v22, s[64:65]
    v_cndmask_b32 v23, 0, v23, s[64:65]
    v_pk_add_f32 v[8:9], v[8:9], v[12:13]
    v_pk_add_f32 v[10:11], v[10:11], v[14:15]
    v_pk_add_f32 v[16:17], v[16:17], v[20:21]
    v_pk_add_f32 v[18:19], v[18:19], v[22:23]
    v_pk_add_f32 v[8:9], v[8:9], v[16:17]
    v_pk_add_f32 v[10:11], v[10:11], v[18:19]
    s_nop 1
    v_permlane32_swap_b32 v8, v10
    v_permlane32_swap_b32 v9, v11
    v_pk_add_f32 v[8:9], v[8:9], v[10:11]
    s_nop 1
    v_permlane16_swap_b32 v8, v9
    v_add_f32 v8, v8, v9
    s_nop 1
    v_add_f32_dpp v8, v8, v8 row_ror:8 row_mask:0xf bank_mask:0xf
    v_cvt_pk_bf16_f32 v8, v8, v8
    v_and_b32 v8, 0xffff0000, v8
    v_mul_f32 v9, v8, v24
    v_cvt_pk_bf16_f32 v9, v9, v9
    v_and_b32 v9, 0xffff0000, v9
    v_add_f32 v9, v9, v28
    v_cvt_pk_bf16_f32 v9, v9, v9
    s_cmp_lg_u32 s9, 0
    s_cbranch_scc1 L7_done
    v_mul_f32 v12, 0xbfb8aa3b, v8
    v_exp_f32 v12, v12
    s_nop 0
    v_add_f32 v12, 1.0, v12
    v_rcp_f32 v12, v12
    s_nop 0
    v_mul_f32 v24, v8, v12
    v_cvt_pk_bf16_f32 v24, v24, v24
    v_and_b32 v24, 0xffff0000, v24
    v_and_b32 v28, 0xffff0000, v28
    v_mov_b32 v30, v29
    v_mov_b32 v31, v32
    s_mov_b64 s[64:65], -1
    s_mov_b32 s9, 1
    s_waitcnt vmcnt(0)
    s_add_u32 s13, s13, 262144
    s_add_u32 s13, s13, 1048576
    s_sub_u32 s15, s86, 40
    s_barrier
    s_cmp_ge_u32 s5, 5
    s_cbranch_scc1 L7_py
    s_barrier
    s_branch L7_py
L7_done:
    s_mov_b32 exec_lo, 0x00ff00ff
    s_mov_b32 exec_hi, 0x00ff00ff
    buffer_store_short v9, v30, s[68:71], s10 offen
    s_mov_b64 exec, -1
    s_cmp_lg_u32 s8, 0
    s_cbranch_scc1 L7_fin
    v_mov_b32 v16, s87
    v_mov_b32 v17, 0
    buffer_store_dword v16, v17, s[56:59], 0 offen sc1
L7_fin:
    s_waitcnt vmcnt(0)
L_end:
    s_endpgm
.section .rodata,"a"
.p2align 6
.amdhsa_kernel recurrent_scan__mha_block_cached__glu_gated_geglu__decode_kernel
  .amdhsa_next_free_vgpr 256
  .amdhsa_next_free_sgpr 102
  .amdhsa_accum_offset 256
  .amdhsa_group_segment_fixed_size 0
  .amdhsa_kernarg_size 96
  .amdhsa_user_sgpr_count 2
  .amdhsa_user_sgpr_kernarg_segment_ptr 1
  .amdhsa_system_sgpr_workgroup_id_x 1
.end_amdhsa_kernel
```
